```python
import torch

def _softmax(x, axis=-1):
    return torch.softmax(x, dim=axis)

def _gelu(x):
    return torch.nn.functional.gelu(x, approximate='tanh')

def _silu(x):
    return torch.nn.functional.silu(x)

def _sigmoid(x):
    return torch.sigmoid(x)

def _layernorm(x, axis=-1, eps=1e-05):
    m = x.mean(dim=axis, keepdim=True)
    v = x.var(dim=axis, keepdim=True, unbiased=False)
    return (x - m) / torch.sqrt(v + eps)

def _scatter_add(tgt, idx, src, axis=0):
    return tgt.clone().index_add_(axis, idx, src)

def _segment_sum(src, seg, n):
    out = torch.zeros((n,) + src.shape[1:], dtype=src.dtype)
    return out.index_add_(0, seg, src)

def _pad(x, pw):
    flat = tuple((v for pair in reversed(pw) for v in pair))
    return torch.nn.functional.pad(x, flat)
kernel_name = 'adaLN_cond__mha_block_cached__glu_gated_geglu__decode'

def setup_inputs():

    _w = lambda a: (lambda t: t.to(torch.bfloat16) if t.is_floating_point() else t)(torch.as_tensor(a))

    def _A_setup():
        B, Sq, D = (1, 1, 640)
        H, Sk, Dh = (32, 32768, 128)
        return {'x': _w((lambda *s: torch.randn(*s, dtype=torch.bfloat16) * 0.1)(B, Sq, D)), 'k_cache': _w((lambda *s: torch.randn(*s, dtype=torch.bfloat16) * 0.8)(B, H, Sk, Dh)), 'v_cache': _w((lambda *s: torch.randn(*s, dtype=torch.bfloat16) * 3.2)(B, H, Sk, Dh)), 'wq': _w((lambda *s: torch.randn(*s, dtype=torch.bfloat16) * 0.8)(D, H * Dh) * D ** (-0.5)), 'wo': _w((lambda *s: torch.randn(*s, dtype=torch.bfloat16) * 3.2)(H * Dh, D) * (H * Dh) ** (-0.5))}
    _A_in = _A_setup()

    def _B_setup():
        B, S, Dm, Df = (1, 1, 640, 1728)
        return {'x': _w((lambda *s: torch.randn(*s, dtype=torch.bfloat16) * 0.1)(B, S, Dm)), 'w_gate': _w((lambda *s: torch.randn(*s, dtype=torch.bfloat16) * 3.2)(Dm, Df) * Dm ** (-0.5)), 'w_up': _w((lambda *s: torch.randn(*s, dtype=torch.bfloat16) * 3.2)(Dm, Df) * Dm ** (-0.5)), 'w_down': _w((lambda *s: torch.randn(*s, dtype=torch.bfloat16) * 3.2)(Df, Dm) * Df ** (-0.5))}
    _B_in = _B_setup()
    return {'A_x': _A_in['x'], 'A_k_cache': _A_in['k_cache'], 'A_v_cache': _A_in['v_cache'], 'A_wq': _A_in['wq'], 'A_wo': _A_in['wo'], 'B_x': _B_in['x'], 'B_w_gate': _B_in['w_gate'], 'B_w_up': _B_in['w_up'], 'B_w_down': _B_in['w_down'], 'c': _w((lambda *s: torch.randn(*s, dtype=torch.bfloat16) * 0.4)(1, 640) * 8.0), 'w_mod': _w((lambda *s: torch.randn(*s, dtype=torch.bfloat16) * 0.4)(640, 6 * 640) * 640 ** (-0.5) * 8.0)}

def reference(A_x, A_k_cache, A_v_cache, A_wq, A_wo, B_x, B_w_gate, B_w_up, B_w_down, c, w_mod):

    def _A_ref(x, k_cache, v_cache, wq, wo):
        B, Sq, D = x.shape
        H, Dh = (32, 128)
        q = (lambda x, *d: x.permute(*d))((x @ wq).reshape(B, Sq, H, Dh), 0, 2, 1, 3)
        scores = torch.einsum('bhqd,bhkd->bhqk', q, k_cache) * Dh ** (-0.5)
        p = _softmax(scores, axis=-1)
        o = torch.einsum('bhqk,bhkd->bhqd', p, v_cache)
        return (lambda x, *d: x.permute(*d))(o, 0, 2, 1, 3).reshape(B, Sq, H * Dh) @ wo

    def _B_ref(x, w_gate, w_up, w_down):
        g = torch.einsum('bsd,df->bsf', x, w_gate)
        u = torch.einsum('bsd,df->bsf', x, w_up)
        h = _gelu(g) * u
        return torch.einsum('bsf,fd->bsd', h, w_down)
    x = A_x
    mod = (_silu(c) @ w_mod).reshape(c.shape[0], 6, 1, -1)
    sa, ca, ga, sb, cb, gb = (mod[:, 0].clone(), mod[:, 1].clone(), mod[:, 2].clone(), mod[:, 3].clone(), mod[:, 4].clone(), mod[:, 5].clone())
    h = _layernorm(x, axis=-1) * (1 + ca) + sa
    x = x + ga * _A_ref(h, A_k_cache, A_v_cache, A_wq, A_wo)
    h = _layernorm(x, axis=-1) * (1 + cb) + sb
    x = x + gb * _B_ref(h, B_w_gate, B_w_up, B_w_down)
    return x
```

```asm
; @launch grid=(256,1,1) block=(768,1,1) lds=143360
.amdgcn_target "amdgcn-amd-amdhsa--gfx950"
.text
.globl adaLN_cond__mha_block_cached__glu_gated_geglu__decode_kernel
.p2align 8
.type adaLN_cond__mha_block_cached__glu_gated_geglu__decode_kernel,@function
adaLN_cond__mha_block_cached__glu_gated_geglu__decode_kernel:
    s_cmp_ge_u32 s2, 256
    s_cbranch_scc1 L_END
    s_load_dwordx16 s[16:31], s[0:1], 0
    s_load_dwordx8 s[32:39], s[0:1], 64
    s_load_dwordx4 s[40:43], s[0:1], 96
    v_lshrrev_b32 v1, 6, v0
    s_nop 0
    v_readfirstlane_b32 s3, v1
    v_and_b32 v1, 63, v0
    s_cmp_ge_u32 s3, 8
    s_cbranch_scc1 L_CW
    s_barrier
    v_lshlrev_b32 v2, 4, v1
    s_lshr_b32 s4, s2, 3
    s_lshl_b32 s56, s4, 23
    s_and_b32 s5, s2, 7
    s_lshl_b32 s5, s5, 20
    s_add_u32 s5, s56, s5
    s_lshl_b32 s7, s3, 12
    s_add_u32 s4, s5, s7
    s_mov_b32 s58, 0
    v_mov_b32 v3, 0
    v_mov_b32 v30, 1
    s_mov_b32 s57, 0
    s_waitcnt lgkmcnt(0)
    s_mov_b32 s44, s18
    s_and_b32 s45, s19, 0xffff
    s_mov_b32 s46, 0x10000000
    s_mov_b32 s47, 0x20000
    s_mov_b32 s48, s20
    s_and_b32 s49, s21, 0xffff
    s_mov_b32 s50, 0x10000000
    s_mov_b32 s51, 0x20000
    s_setprio 1
    s_barrier
    s_mov_b32 s7, s4
    s_add_u32 s4, s4, 32768
    buffer_load_dwordx4 v[36:39], v2, s[44:47], s7 offen offset:0 nt
    buffer_load_dwordx4 v[40:43], v2, s[44:47], s7 offen offset:1024 nt
    buffer_load_dwordx4 v[44:47], v2, s[44:47], s7 offen offset:2048 nt
    buffer_load_dwordx4 v[48:51], v2, s[44:47], s7 offen offset:3072 nt
    s_waitcnt vmcnt(8)
    buffer_load_dwordx4 v[52:55], v2, s[48:51], s7 offen offset:0 nt
    buffer_load_dwordx4 v[56:59], v2, s[48:51], s7 offen offset:1024 nt
    buffer_load_dwordx4 v[60:63], v2, s[48:51], s7 offen offset:2048 nt
    buffer_load_dwordx4 v[64:67], v2, s[48:51], s7 offen offset:3072 nt
    s_mov_b32 s7, s4
    s_add_u32 s4, s4, 32768
    s_waitcnt vmcnt(8)
    buffer_load_dwordx4 v[68:71], v2, s[44:47], s7 offen offset:0 nt
    buffer_load_dwordx4 v[72:75], v2, s[44:47], s7 offen offset:1024 nt
    buffer_load_dwordx4 v[76:79], v2, s[44:47], s7 offen offset:2048 nt
    buffer_load_dwordx4 v[80:83], v2, s[44:47], s7 offen offset:3072 nt
    s_waitcnt vmcnt(8)
    buffer_load_dwordx4 v[84:87], v2, s[48:51], s7 offen offset:0 nt
    buffer_load_dwordx4 v[88:91], v2, s[48:51], s7 offen offset:1024 nt
    buffer_load_dwordx4 v[92:95], v2, s[48:51], s7 offen offset:2048 nt
    buffer_load_dwordx4 v[96:99], v2, s[48:51], s7 offen offset:3072 nt
    s_mov_b32 s7, s4
    s_add_u32 s4, s4, 32768
    s_waitcnt vmcnt(8)
    buffer_load_dwordx4 v[100:103], v2, s[44:47], s7 offen offset:0 nt
    buffer_load_dwordx4 v[104:107], v2, s[44:47], s7 offen offset:1024 nt
    buffer_load_dwordx4 v[108:111], v2, s[44:47], s7 offen offset:2048 nt
    buffer_load_dwordx4 v[112:115], v2, s[44:47], s7 offen offset:3072 nt
    s_waitcnt vmcnt(8)
    buffer_load_dwordx4 v[116:119], v2, s[48:51], s7 offen offset:0 nt
    buffer_load_dwordx4 v[120:123], v2, s[48:51], s7 offen offset:1024 nt
    buffer_load_dwordx4 v[124:127], v2, s[48:51], s7 offen offset:2048 nt
    buffer_load_dwordx4 v[128:131], v2, s[48:51], s7 offen offset:3072 nt
    s_mov_b32 s7, s4
    s_add_u32 s4, s4, 32768
    s_waitcnt vmcnt(8)
    buffer_load_dwordx4 v[132:135], v2, s[44:47], s7 offen offset:0 nt
    buffer_load_dwordx4 v[136:139], v2, s[44:47], s7 offen offset:1024 nt
    buffer_load_dwordx4 v[140:143], v2, s[44:47], s7 offen offset:2048 nt
    buffer_load_dwordx4 v[144:147], v2, s[44:47], s7 offen offset:3072 nt
    s_waitcnt vmcnt(8)
    buffer_load_dwordx4 v[148:151], v2, s[48:51], s7 offen offset:0 nt
    buffer_load_dwordx4 v[152:155], v2, s[48:51], s7 offen offset:1024 nt
    buffer_load_dwordx4 v[156:159], v2, s[48:51], s7 offen offset:2048 nt
    buffer_load_dwordx4 v[160:163], v2, s[48:51], s7 offen offset:3072 nt
    v_mov_b32 v8, 0xff800000
    v_mov_b32 v9, 0
    v_mov_b32 v10, 0
    v_mov_b32 v11, 0
    v_mov_b32 v12, 0
    v_mov_b32 v13, 0
    v_mov_b32 v14, 0
    v_mov_b32 v15, 0
    v_mov_b32 v16, 0
    v_mov_b32 v17, 0
    v_and_b32 v25, 15, v1
    v_lshlrev_b32 v25, 4, v25
    s_mov_b32 s8, 0x3db504f3
    s_mov_b32 s9, 0x3fb8aa3b
    s_mov_b32 s10, 0xffff0000
    s_barrier
    s_setprio 0
    ds_read_b128 v[4:7], v25 offset:0
    s_waitcnt lgkmcnt(0)
    s_mov_b64 exec, 1
    ds_add_rtn_u32 v29, v3, v30 offset:11840
    s_mov_b64 exec, -1
    s_waitcnt vmcnt(28)
    v_dot2_f32_bf16 v18, v36, v4, 0
    v_dot2_f32_bf16 v19, v40, v4, 0
    v_dot2_f32_bf16 v20, v44, v4, 0
    v_dot2_f32_bf16 v21, v48, v4, 0
    v_dot2_f32_bf16 v18, v37, v5, v18
    v_dot2_f32_bf16 v19, v41, v5, v19
    v_dot2_f32_bf16 v20, v45, v5, v20
    v_dot2_f32_bf16 v21, v49, v5, v21
    v_dot2_f32_bf16 v18, v38, v6, v18
    v_dot2_f32_bf16 v19, v42, v6, v19
    v_dot2_f32_bf16 v20, v46, v6, v20
    v_dot2_f32_bf16 v21, v50, v6, v21
    v_dot2_f32_bf16 v18, v39, v7, v18
    v_dot2_f32_bf16 v19, v43, v7, v19
    v_dot2_f32_bf16 v20, v47, v7, v20
    v_dot2_f32_bf16 v21, v51, v7, v21
    v_add_f32_dpp v22, v18, v18 row_ror:8 row_mask:0xf bank_mask:0x3
    v_add_f32_dpp v23, v19, v19 row_ror:8 row_mask:0xf bank_mask:0x3
    s_nop 0
    v_add_f32_dpp v22, v20, v20 row_ror:8 row_mask:0xf bank_mask:0xc
    s_nop 0
    v_add_f32_dpp v23, v21, v21 row_ror:8 row_mask:0xf bank_mask:0xc
    s_nop 0
    v_add_f32_dpp v24, v22, v22 row_half_mirror row_mask:0xf bank_mask:0x5
    s_nop 1
    v_add_f32_dpp v24, v23, v23 row_half_mirror row_mask:0xf bank_mask:0xa
    s_nop 1
    v_add_f32_dpp v24, v24, v24 quad_perm:[1,0,3,2] row_mask:0xf bank_mask:0xf
    s_nop 1
    v_add_f32_dpp v24, v24, v24 quad_perm:[2,3,0,1] row_mask:0xf bank_mask:0xf
    v_cvt_pk_bf16_f32 v24, v24, v24
    v_and_b32 v24, s10, v24
    v_mul_f32 v24, s8, v24
    v_cvt_pk_bf16_f32 v24, v24, v24
    v_and_b32 v24, s10, v24
    s_nop 1
    v_max_f32_dpp v22, v24, v24 row_ror:4 row_mask:0xf bank_mask:0xf
    s_nop 1
    v_max_f32_dpp v22, v22, v22 row_ror:8 row_mask:0xf bank_mask:0xf
    v_max_f32 v28, v8, v22
    v_sub_f32 v27, v8, v28
    v_sub_f32 v26, v24, v28
    v_mul_f32 v27, s9, v27
    v_mul_f32 v26, s9, v26
    v_exp_f32 v27, v27
    v_exp_f32 v26, v26
    v_mov_b32 v8, v28
    v_fma_f32 v9, v9, v27, v26
    v_mul_f32 v10, v10, v27
    v_mul_f32 v11, v11, v27
    v_mul_f32 v12, v12, v27
    v_mul_f32 v13, v13, v27
    v_mul_f32 v14, v14, v27
    v_mul_f32 v15, v15, v27
    v_mul_f32 v16, v16, v27
    v_mul_f32 v17, v17, v27
    s_waitcnt vmcnt(24)
    v_lshlrev_b32 v18, 16, v52
    v_and_b32 v19, s10, v52
    v_lshlrev_b32 v20, 16, v53
    v_and_b32 v21, s10, v53
    v_lshlrev_b32 v22, 16, v54
    v_and_b32 v23, s10, v54
    v_lshlrev_b32 v24, 16, v55
    v_and_b32 v25, s10, v55
    v_fmac_f32_dpp v10, v26, v18 row_newbcast:0 row_mask:0xf bank_mask:0xf
    v_fmac_f32_dpp v11, v26, v19 row_newbcast:0 row_mask:0xf bank_mask:0xf
    v_fmac_f32_dpp v12, v26, v20 row_newbcast:0 row_mask:0xf bank_mask:0xf
    v_fmac_f32_dpp v13, v26, v21 row_newbcast:0 row_mask:0xf bank_mask:0xf
    v_fmac_f32_dpp v14, v26, v22 row_newbcast:0 row_mask:0xf bank_mask:0xf
    v_fmac_f32_dpp v15, v26, v23 row_newbcast:0 row_mask:0xf bank_mask:0xf
    v_fmac_f32_dpp v16, v26, v24 row_newbcast:0 row_mask:0xf bank_mask:0xf
    v_fmac_f32_dpp v17, v26, v25 row_newbcast:0 row_mask:0xf bank_mask:0xf
    v_lshlrev_b32 v18, 16, v56
    v_and_b32 v19, s10, v56
    v_lshlrev_b32 v20, 16, v57
    v_and_b32 v21, s10, v57
    v_lshlrev_b32 v22, 16, v58
    v_and_b32 v23, s10, v58
    v_lshlrev_b32 v24, 16, v59
    v_and_b32 v25, s10, v59
    v_fmac_f32_dpp v10, v26, v18 row_newbcast:4 row_mask:0xf bank_mask:0xf
    v_fmac_f32_dpp v11, v26, v19 row_newbcast:4 row_mask:0xf bank_mask:0xf
    v_fmac_f32_dpp v12, v26, v20 row_newbcast:4 row_mask:0xf bank_mask:0xf
    v_fmac_f32_dpp v13, v26, v21 row_newbcast:4 row_mask:0xf bank_mask:0xf
    v_fmac_f32_dpp v14, v26, v22 row_newbcast:4 row_mask:0xf bank_mask:0xf
    v_fmac_f32_dpp v15, v26, v23 row_newbcast:4 row_mask:0xf bank_mask:0xf
    v_fmac_f32_dpp v16, v26, v24 row_newbcast:4 row_mask:0xf bank_mask:0xf
    v_fmac_f32_dpp v17, v26, v25 row_newbcast:4 row_mask:0xf bank_mask:0xf
    v_lshlrev_b32 v18, 16, v60
    v_and_b32 v19, s10, v60
    v_lshlrev_b32 v20, 16, v61
    v_and_b32 v21, s10, v61
    v_lshlrev_b32 v22, 16, v62
    v_and_b32 v23, s10, v62
    v_lshlrev_b32 v24, 16, v63
    v_and_b32 v25, s10, v63
    v_fmac_f32_dpp v10, v26, v18 row_newbcast:8 row_mask:0xf bank_mask:0xf
    v_fmac_f32_dpp v11, v26, v19 row_newbcast:8 row_mask:0xf bank_mask:0xf
    v_fmac_f32_dpp v12, v26, v20 row_newbcast:8 row_mask:0xf bank_mask:0xf
    v_fmac_f32_dpp v13, v26, v21 row_newbcast:8 row_mask:0xf bank_mask:0xf
    v_fmac_f32_dpp v14, v26, v22 row_newbcast:8 row_mask:0xf bank_mask:0xf
    v_fmac_f32_dpp v15, v26, v23 row_newbcast:8 row_mask:0xf bank_mask:0xf
    v_fmac_f32_dpp v16, v26, v24 row_newbcast:8 row_mask:0xf bank_mask:0xf
    v_fmac_f32_dpp v17, v26, v25 row_newbcast:8 row_mask:0xf bank_mask:0xf
    v_lshlrev_b32 v18, 16, v64
    v_and_b32 v19, s10, v64
    v_lshlrev_b32 v20, 16, v65
    v_and_b32 v21, s10, v65
    v_lshlrev_b32 v22, 16, v66
    v_and_b32 v23, s10, v66
    v_lshlrev_b32 v24, 16, v67
    v_and_b32 v25, s10, v67
    v_fmac_f32_dpp v10, v26, v18 row_newbcast:12 row_mask:0xf bank_mask:0xf
    v_fmac_f32_dpp v11, v26, v19 row_newbcast:12 row_mask:0xf bank_mask:0xf
    v_fmac_f32_dpp v12, v26, v20 row_newbcast:12 row_mask:0xf bank_mask:0xf
    v_fmac_f32_dpp v13, v26, v21 row_newbcast:12 row_mask:0xf bank_mask:0xf
    v_fmac_f32_dpp v14, v26, v22 row_newbcast:12 row_mask:0xf bank_mask:0xf
    v_fmac_f32_dpp v15, v26, v23 row_newbcast:12 row_mask:0xf bank_mask:0xf
    v_fmac_f32_dpp v16, v26, v24 row_newbcast:12 row_mask:0xf bank_mask:0xf
    v_fmac_f32_dpp v17, v26, v25 row_newbcast:12 row_mask:0xf bank_mask:0xf
    s_waitcnt lgkmcnt(0)
    v_readfirstlane_b32 s12, v29
    s_nop 0
    s_cmp_ge_u32 s12, 160
    s_cbranch_scc1 L_mp_1
    s_lshl_b32 s7, s12, 12
    s_add_u32 s7, s7, s5
    s_mov_b32 s52, 1
    s_branch L_mgo_3
L_mp_1:
    s_sub_u32 s12, s12, 160
    s_lshl_b32 s12, s12, 2
    v_mov_b32 v25, s12
    s_mov_b32 s60, 0
L_msp_2:
    s_add_u32 s60, s60, 1
    s_cmp_gt_u32 s60, 12800000
    s_cbranch_scc1 L_mend_4
    ds_read_b32 v29, v25 offset:12288
    s_waitcnt lgkmcnt(0)
    v_readfirstlane_b32 s13, v29
    s_nop 0
    s_cmp_eq_u32 s13, -1
    s_cbranch_scc1 L_msp_2
    s_cmp_eq_u32 s13, -2
    s_cbranch_scc1 L_mend_4
    s_add_u32 s7, s13, s56
    s_mov_b32 s52, 1
    s_branch L_mgo_3
L_mend_4:
    s_mov_b32 s7, 0x40000000
    s_mov_b32 s52, 0
L_mgo_3:
    s_cmp_eq_u32 s52, 0
    s_cselect_b32 s57, 1, s57
    s_cbranch_scc1 L_noiss_5
    buffer_load_dwordx4 v[36:39], v2, s[44:47], s7 offen offset:0 nt
    buffer_load_dwordx4 v[40:43], v2, s[44:47], s7 offen offset:1024 nt
    buffer_load_dwordx4 v[44:47], v2, s[44:47], s7 offen offset:2048 nt
    buffer_load_dwordx4 v[48:51], v2, s[44:47], s7 offen offset:3072 nt
    buffer_load_dwordx4 v[52:55], v2, s[48:51], s7 offen offset:0 nt
    buffer_load_dwordx4 v[56:59], v2, s[48:51], s7 offen offset:1024 nt
    buffer_load_dwordx4 v[60:63], v2, s[48:51], s7 offen offset:2048 nt
    buffer_load_dwordx4 v[64:67], v2, s[48:51], s7 offen offset:3072 nt
L_noiss_5:
    s_mov_b64 exec, 1
    ds_add_rtn_u32 v29, v3, v30 offset:11840
    s_mov_b64 exec, -1
    s_waitcnt vmcnt(28)
    v_dot2_f32_bf16 v18, v68, v4, 0
    v_dot2_f32_bf16 v19, v72, v4, 0
    v_dot2_f32_bf16 v20, v76, v4, 0
    v_dot2_f32_bf16 v21, v80, v4, 0
    v_dot2_f32_bf16 v18, v69, v5, v18
    v_dot2_f32_bf16 v19, v73, v5, v19
    v_dot2_f32_bf16 v20, v77, v5, v20
    v_dot2_f32_bf16 v21, v81, v5, v21
    v_dot2_f32_bf16 v18, v70, v6, v18
    v_dot2_f32_bf16 v19, v74, v6, v19
    v_dot2_f32_bf16 v20, v78, v6, v20
    v_dot2_f32_bf16 v21, v82, v6, v21
    v_dot2_f32_bf16 v18, v71, v7, v18
    v_dot2_f32_bf16 v19, v75, v7, v19
    v_dot2_f32_bf16 v20, v79, v7, v20
    v_dot2_f32_bf16 v21, v83, v7, v21
    v_add_f32_dpp v22, v18, v18 row_ror:8 row_mask:0xf bank_mask:0x3
    v_add_f32_dpp v23, v19, v19 row_ror:8 row_mask:0xf bank_mask:0x3
    s_nop 0
    v_add_f32_dpp v22, v20, v20 row_ror:8 row_mask:0xf bank_mask:0xc
    s_nop 0
    v_add_f32_dpp v23, v21, v21 row_ror:8 row_mask:0xf bank_mask:0xc
    s_nop 0
    v_add_f32_dpp v24, v22, v22 row_half_mirror row_mask:0xf bank_mask:0x5
    s_nop 1
    v_add_f32_dpp v24, v23, v23 row_half_mirror row_mask:0xf bank_mask:0xa
    s_nop 1
    v_add_f32_dpp v24, v24, v24 quad_perm:[1,0,3,2] row_mask:0xf bank_mask:0xf
    s_nop 1
    v_add_f32_dpp v24, v24, v24 quad_perm:[2,3,0,1] row_mask:0xf bank_mask:0xf
    v_cvt_pk_bf16_f32 v24, v24, v24
    v_and_b32 v24, s10, v24
    v_mul_f32 v24, s8, v24
    v_cvt_pk_bf16_f32 v24, v24, v24
    v_and_b32 v24, s10, v24
    s_nop 1
    v_max_f32_dpp v22, v24, v24 row_ror:4 row_mask:0xf bank_mask:0xf
    s_nop 1
    v_max_f32_dpp v22, v22, v22 row_ror:8 row_mask:0xf bank_mask:0xf
    v_max_f32 v28, v8, v22
    v_sub_f32 v27, v8, v28
    v_sub_f32 v26, v24, v28
    v_mul_f32 v27, s9, v27
    v_mul_f32 v26, s9, v26
    v_exp_f32 v27, v27
    v_exp_f32 v26, v26
    v_mov_b32 v8, v28
    v_fma_f32 v9, v9, v27, v26
    v_mul_f32 v10, v10, v27
    v_mul_f32 v11, v11, v27
    v_mul_f32 v12, v12, v27
    v_mul_f32 v13, v13, v27
    v_mul_f32 v14, v14, v27
    v_mul_f32 v15, v15, v27
    v_mul_f32 v16, v16, v27
    v_mul_f32 v17, v17, v27
    s_waitcnt vmcnt(24)
    v_lshlrev_b32 v18, 16, v84
    v_and_b32 v19, s10, v84
    v_lshlrev_b32 v20, 16, v85
    v_and_b32 v21, s10, v85
    v_lshlrev_b32 v22, 16, v86
    v_and_b32 v23, s10, v86
    v_lshlrev_b32 v24, 16, v87
    v_and_b32 v25, s10, v87
    v_fmac_f32_dpp v10, v26, v18 row_newbcast:0 row_mask:0xf bank_mask:0xf
    v_fmac_f32_dpp v11, v26, v19 row_newbcast:0 row_mask:0xf bank_mask:0xf
    v_fmac_f32_dpp v12, v26, v20 row_newbcast:0 row_mask:0xf bank_mask:0xf
    v_fmac_f32_dpp v13, v26, v21 row_newbcast:0 row_mask:0xf bank_mask:0xf
    v_fmac_f32_dpp v14, v26, v22 row_newbcast:0 row_mask:0xf bank_mask:0xf
    v_fmac_f32_dpp v15, v26, v23 row_newbcast:0 row_mask:0xf bank_mask:0xf
    v_fmac_f32_dpp v16, v26, v24 row_newbcast:0 row_mask:0xf bank_mask:0xf
    v_fmac_f32_dpp v17, v26, v25 row_newbcast:0 row_mask:0xf bank_mask:0xf
    v_lshlrev_b32 v18, 16, v88
    v_and_b32 v19, s10, v88
    v_lshlrev_b32 v20, 16, v89
    v_and_b32 v21, s10, v89
    v_lshlrev_b32 v22, 16, v90
    v_and_b32 v23, s10, v90
    v_lshlrev_b32 v24, 16, v91
    v_and_b32 v25, s10, v91
    v_fmac_f32_dpp v10, v26, v18 row_newbcast:4 row_mask:0xf bank_mask:0xf
    v_fmac_f32_dpp v11, v26, v19 row_newbcast:4 row_mask:0xf bank_mask:0xf
    v_fmac_f32_dpp v12, v26, v20 row_newbcast:4 row_mask:0xf bank_mask:0xf
    v_fmac_f32_dpp v13, v26, v21 row_newbcast:4 row_mask:0xf bank_mask:0xf
    v_fmac_f32_dpp v14, v26, v22 row_newbcast:4 row_mask:0xf bank_mask:0xf
    v_fmac_f32_dpp v15, v26, v23 row_newbcast:4 row_mask:0xf bank_mask:0xf
    v_fmac_f32_dpp v16, v26, v24 row_newbcast:4 row_mask:0xf bank_mask:0xf
    v_fmac_f32_dpp v17, v26, v25 row_newbcast:4 row_mask:0xf bank_mask:0xf
    v_lshlrev_b32 v18, 16, v92
    v_and_b32 v19, s10, v92
    v_lshlrev_b32 v20, 16, v93
    v_and_b32 v21, s10, v93
    v_lshlrev_b32 v22, 16, v94
    v_and_b32 v23, s10, v94
    v_lshlrev_b32 v24, 16, v95
    v_and_b32 v25, s10, v95
    v_fmac_f32_dpp v10, v26, v18 row_newbcast:8 row_mask:0xf bank_mask:0xf
    v_fmac_f32_dpp v11, v26, v19 row_newbcast:8 row_mask:0xf bank_mask:0xf
    v_fmac_f32_dpp v12, v26, v20 row_newbcast:8 row_mask:0xf bank_mask:0xf
    v_fmac_f32_dpp v13, v26, v21 row_newbcast:8 row_mask:0xf bank_mask:0xf
    v_fmac_f32_dpp v14, v26, v22 row_newbcast:8 row_mask:0xf bank_mask:0xf
    v_fmac_f32_dpp v15, v26, v23 row_newbcast:8 row_mask:0xf bank_mask:0xf
    v_fmac_f32_dpp v16, v26, v24 row_newbcast:8 row_mask:0xf bank_mask:0xf
    v_fmac_f32_dpp v17, v26, v25 row_newbcast:8 row_mask:0xf bank_mask:0xf
    v_lshlrev_b32 v18, 16, v96
    v_and_b32 v19, s10, v96
    v_lshlrev_b32 v20, 16, v97
    v_and_b32 v21, s10, v97
    v_lshlrev_b32 v22, 16, v98
    v_and_b32 v23, s10, v98
    v_lshlrev_b32 v24, 16, v99
    v_and_b32 v25, s10, v99
    v_fmac_f32_dpp v10, v26, v18 row_newbcast:12 row_mask:0xf bank_mask:0xf
    v_fmac_f32_dpp v11, v26, v19 row_newbcast:12 row_mask:0xf bank_mask:0xf
    v_fmac_f32_dpp v12, v26, v20 row_newbcast:12 row_mask:0xf bank_mask:0xf
    v_fmac_f32_dpp v13, v26, v21 row_newbcast:12 row_mask:0xf bank_mask:0xf
    v_fmac_f32_dpp v14, v26, v22 row_newbcast:12 row_mask:0xf bank_mask:0xf
    v_fmac_f32_dpp v15, v26, v23 row_newbcast:12 row_mask:0xf bank_mask:0xf
    v_fmac_f32_dpp v16, v26, v24 row_newbcast:12 row_mask:0xf bank_mask:0xf
    v_fmac_f32_dpp v17, v26, v25 row_newbcast:12 row_mask:0xf bank_mask:0xf
    s_waitcnt lgkmcnt(0)
    v_readfirstlane_b32 s12, v29
    s_nop 0
    s_cmp_ge_u32 s12, 160
    s_cbranch_scc1 L_mp_6
    s_lshl_b32 s7, s12, 12
    s_add_u32 s7, s7, s5
    s_mov_b32 s53, 1
    s_branch L_mgo_8
L_mp_6:
    s_sub_u32 s12, s12, 160
    s_lshl_b32 s12, s12, 2
    v_mov_b32 v25, s12
    s_mov_b32 s60, 0
L_msp_7:
    s_add_u32 s60, s60, 1
    s_cmp_gt_u32 s60, 12800000
    s_cbranch_scc1 L_mend_9
    ds_read_b32 v29, v25 offset:12288
    s_waitcnt lgkmcnt(0)
    v_readfirstlane_b32 s13, v29
    s_nop 0
    s_cmp_eq_u32 s13, -1
    s_cbranch_scc1 L_msp_7
    s_cmp_eq_u32 s13, -2
    s_cbranch_scc1 L_mend_9
    s_add_u32 s7, s13, s56
    s_mov_b32 s53, 1
    s_branch L_mgo_8
L_mend_9:
    s_mov_b32 s7, 0x40000000
    s_mov_b32 s53, 0
L_mgo_8:
    s_cmp_eq_u32 s53, 0
    s_cselect_b32 s57, 1, s57
    s_cbranch_scc1 L_noiss_10
    buffer_load_dwordx4 v[68:71], v2, s[44:47], s7 offen offset:0 nt
    buffer_load_dwordx4 v[72:75], v2, s[44:47], s7 offen offset:1024 nt
    buffer_load_dwordx4 v[76:79], v2, s[44:47], s7 offen offset:2048 nt
    buffer_load_dwordx4 v[80:83], v2, s[44:47], s7 offen offset:3072 nt
    buffer_load_dwordx4 v[84:87], v2, s[48:51], s7 offen offset:0 nt
    buffer_load_dwordx4 v[88:91], v2, s[48:51], s7 offen offset:1024 nt
    buffer_load_dwordx4 v[92:95], v2, s[48:51], s7 offen offset:2048 nt
    buffer_load_dwordx4 v[96:99], v2, s[48:51], s7 offen offset:3072 nt
L_noiss_10:
    s_waitcnt vmcnt(28)
    v_dot2_f32_bf16 v18, v100, v4, 0
    v_dot2_f32_bf16 v19, v104, v4, 0
    v_dot2_f32_bf16 v20, v108, v4, 0
    v_dot2_f32_bf16 v21, v112, v4, 0
    v_dot2_f32_bf16 v18, v101, v5, v18
    v_dot2_f32_bf16 v19, v105, v5, v19
    v_dot2_f32_bf16 v20, v109, v5, v20
    v_dot2_f32_bf16 v21, v113, v5, v21
    v_dot2_f32_bf16 v18, v102, v6, v18
    v_dot2_f32_bf16 v19, v106, v6, v19
    v_dot2_f32_bf16 v20, v110, v6, v20
    v_dot2_f32_bf16 v21, v114, v6, v21
    v_dot2_f32_bf16 v18, v103, v7, v18
    v_dot2_f32_bf16 v19, v107, v7, v19
    v_dot2_f32_bf16 v20, v111, v7, v20
    v_dot2_f32_bf16 v21, v115, v7, v21
    v_add_f32_dpp v22, v18, v18 row_ror:8 row_mask:0xf bank_mask:0x3
    v_add_f32_dpp v23, v19, v19 row_ror:8 row_mask:0xf bank_mask:0x3
    s_nop 0
    v_add_f32_dpp v22, v20, v20 row_ror:8 row_mask:0xf bank_mask:0xc
    s_nop 0
    v_add_f32_dpp v23, v21, v21 row_ror:8 row_mask:0xf bank_mask:0xc
    s_nop 0
    v_add_f32_dpp v24, v22, v22 row_half_mirror row_mask:0xf bank_mask:0x5
    s_nop 1
    v_add_f32_dpp v24, v23, v23 row_half_mirror row_mask:0xf bank_mask:0xa
    s_nop 1
    v_add_f32_dpp v24, v24, v24 quad_perm:[1,0,3,2] row_mask:0xf bank_mask:0xf
    s_nop 1
    v_add_f32_dpp v24, v24, v24 quad_perm:[2,3,0,1] row_mask:0xf bank_mask:0xf
    v_cvt_pk_bf16_f32 v24, v24, v24
    v_and_b32 v24, s10, v24
    v_mul_f32 v24, s8, v24
    v_cvt_pk_bf16_f32 v24, v24, v24
    v_and_b32 v24, s10, v24
    s_nop 1
    v_max_f32_dpp v22, v24, v24 row_ror:4 row_mask:0xf bank_mask:0xf
    s_nop 1
    v_max_f32_dpp v22, v22, v22 row_ror:8 row_mask:0xf bank_mask:0xf
    v_max_f32 v28, v8, v22
    v_sub_f32 v27, v8, v28
    v_sub_f32 v26, v24, v28
    v_mul_f32 v27, s9, v27
    v_mul_f32 v26, s9, v26
    v_exp_f32 v27, v27
    v_exp_f32 v26, v26
    v_mov_b32 v8, v28
    v_fma_f32 v9, v9, v27, v26
    v_mul_f32 v10, v10, v27
    v_mul_f32 v11, v11, v27
    v_mul_f32 v12, v12, v27
    v_mul_f32 v13, v13, v27
    v_mul_f32 v14, v14, v27
    v_mul_f32 v15, v15, v27
    v_mul_f32 v16, v16, v27
    v_mul_f32 v17, v17, v27
    s_waitcnt vmcnt(24)
    v_lshlrev_b32 v18, 16, v116
    v_and_b32 v19, s10, v116
    v_lshlrev_b32 v20, 16, v117
    v_and_b32 v21, s10, v117
    v_lshlrev_b32 v22, 16, v118
    v_and_b32 v23, s10, v118
    v_lshlrev_b32 v24, 16, v119
    v_and_b32 v25, s10, v119
    v_fmac_f32_dpp v10, v26, v18 row_newbcast:0 row_mask:0xf bank_mask:0xf
    v_fmac_f32_dpp v11, v26, v19 row_newbcast:0 row_mask:0xf bank_mask:0xf
    v_fmac_f32_dpp v12, v26, v20 row_newbcast:0 row_mask:0xf bank_mask:0xf
    v_fmac_f32_dpp v13, v26, v21 row_newbcast:0 row_mask:0xf bank_mask:0xf
    v_fmac_f32_dpp v14, v26, v22 row_newbcast:0 row_mask:0xf bank_mask:0xf
    v_fmac_f32_dpp v15, v26, v23 row_newbcast:0 row_mask:0xf bank_mask:0xf
    v_fmac_f32_dpp v16, v26, v24 row_newbcast:0 row_mask:0xf bank_mask:0xf
    v_fmac_f32_dpp v17, v26, v25 row_newbcast:0 row_mask:0xf bank_mask:0xf
    v_lshlrev_b32 v18, 16, v120
    v_and_b32 v19, s10, v120
    v_lshlrev_b32 v20, 16, v121
    v_and_b32 v21, s10, v121
    v_lshlrev_b32 v22, 16, v122
    v_and_b32 v23, s10, v122
    v_lshlrev_b32 v24, 16, v123
    v_and_b32 v25, s10, v123
    v_fmac_f32_dpp v10, v26, v18 row_newbcast:4 row_mask:0xf bank_mask:0xf
    v_fmac_f32_dpp v11, v26, v19 row_newbcast:4 row_mask:0xf bank_mask:0xf
    v_fmac_f32_dpp v12, v26, v20 row_newbcast:4 row_mask:0xf bank_mask:0xf
    v_fmac_f32_dpp v13, v26, v21 row_newbcast:4 row_mask:0xf bank_mask:0xf
    v_fmac_f32_dpp v14, v26, v22 row_newbcast:4 row_mask:0xf bank_mask:0xf
    v_fmac_f32_dpp v15, v26, v23 row_newbcast:4 row_mask:0xf bank_mask:0xf
    v_fmac_f32_dpp v16, v26, v24 row_newbcast:4 row_mask:0xf bank_mask:0xf
    v_fmac_f32_dpp v17, v26, v25 row_newbcast:4 row_mask:0xf bank_mask:0xf
    v_lshlrev_b32 v18, 16, v124
    v_and_b32 v19, s10, v124
    v_lshlrev_b32 v20, 16, v125
    v_and_b32 v21, s10, v125
    v_lshlrev_b32 v22, 16, v126
    v_and_b32 v23, s10, v126
    v_lshlrev_b32 v24, 16, v127
    v_and_b32 v25, s10, v127
    v_fmac_f32_dpp v10, v26, v18 row_newbcast:8 row_mask:0xf bank_mask:0xf
    v_fmac_f32_dpp v11, v26, v19 row_newbcast:8 row_mask:0xf bank_mask:0xf
    v_fmac_f32_dpp v12, v26, v20 row_newbcast:8 row_mask:0xf bank_mask:0xf
    v_fmac_f32_dpp v13, v26, v21 row_newbcast:8 row_mask:0xf bank_mask:0xf
    v_fmac_f32_dpp v14, v26, v22 row_newbcast:8 row_mask:0xf bank_mask:0xf
    v_fmac_f32_dpp v15, v26, v23 row_newbcast:8 row_mask:0xf bank_mask:0xf
    v_fmac_f32_dpp v16, v26, v24 row_newbcast:8 row_mask:0xf bank_mask:0xf
    v_fmac_f32_dpp v17, v26, v25 row_newbcast:8 row_mask:0xf bank_mask:0xf
    v_lshlrev_b32 v18, 16, v128
    v_and_b32 v19, s10, v128
    v_lshlrev_b32 v20, 16, v129
    v_and_b32 v21, s10, v129
    v_lshlrev_b32 v22, 16, v130
    v_and_b32 v23, s10, v130
    v_lshlrev_b32 v24, 16, v131
    v_and_b32 v25, s10, v131
    v_fmac_f32_dpp v10, v26, v18 row_newbcast:12 row_mask:0xf bank_mask:0xf
    v_fmac_f32_dpp v11, v26, v19 row_newbcast:12 row_mask:0xf bank_mask:0xf
    v_fmac_f32_dpp v12, v26, v20 row_newbcast:12 row_mask:0xf bank_mask:0xf
    v_fmac_f32_dpp v13, v26, v21 row_newbcast:12 row_mask:0xf bank_mask:0xf
    v_fmac_f32_dpp v14, v26, v22 row_newbcast:12 row_mask:0xf bank_mask:0xf
    v_fmac_f32_dpp v15, v26, v23 row_newbcast:12 row_mask:0xf bank_mask:0xf
    v_fmac_f32_dpp v16, v26, v24 row_newbcast:12 row_mask:0xf bank_mask:0xf
    v_fmac_f32_dpp v17, v26, v25 row_newbcast:12 row_mask:0xf bank_mask:0xf
    s_waitcnt vmcnt(20)
    v_dot2_f32_bf16 v18, v132, v4, 0
    v_dot2_f32_bf16 v19, v136, v4, 0
    v_dot2_f32_bf16 v20, v140, v4, 0
    v_dot2_f32_bf16 v21, v144, v4, 0
    v_dot2_f32_bf16 v18, v133, v5, v18
    v_dot2_f32_bf16 v19, v137, v5, v19
    v_dot2_f32_bf16 v20, v141, v5, v20
    v_dot2_f32_bf16 v21, v145, v5, v21
    v_dot2_f32_bf16 v18, v134, v6, v18
    v_dot2_f32_bf16 v19, v138, v6, v19
    v_dot2_f32_bf16 v20, v142, v6, v20
    v_dot2_f32_bf16 v21, v146, v6, v21
    v_dot2_f32_bf16 v18, v135, v7, v18
    v_dot2_f32_bf16 v19, v139, v7, v19
    v_dot2_f32_bf16 v20, v143, v7, v20
    v_dot2_f32_bf16 v21, v147, v7, v21
    v_add_f32_dpp v22, v18, v18 row_ror:8 row_mask:0xf bank_mask:0x3
    v_add_f32_dpp v23, v19, v19 row_ror:8 row_mask:0xf bank_mask:0x3
    s_nop 0
    v_add_f32_dpp v22, v20, v20 row_ror:8 row_mask:0xf bank_mask:0xc
    s_nop 0
    v_add_f32_dpp v23, v21, v21 row_ror:8 row_mask:0xf bank_mask:0xc
    s_nop 0
    v_add_f32_dpp v24, v22, v22 row_half_mirror row_mask:0xf bank_mask:0x5
    s_nop 1
    v_add_f32_dpp v24, v23, v23 row_half_mirror row_mask:0xf bank_mask:0xa
    s_nop 1
    v_add_f32_dpp v24, v24, v24 quad_perm:[1,0,3,2] row_mask:0xf bank_mask:0xf
    s_nop 1
    v_add_f32_dpp v24, v24, v24 quad_perm:[2,3,0,1] row_mask:0xf bank_mask:0xf
    v_cvt_pk_bf16_f32 v24, v24, v24
    v_and_b32 v24, s10, v24
    v_mul_f32 v24, s8, v24
    v_cvt_pk_bf16_f32 v24, v24, v24
    v_and_b32 v24, s10, v24
    s_nop 1
    v_max_f32_dpp v22, v24, v24 row_ror:4 row_mask:0xf bank_mask:0xf
    s_nop 1
    v_max_f32_dpp v22, v22, v22 row_ror:8 row_mask:0xf bank_mask:0xf
    v_max_f32 v28, v8, v22
    v_sub_f32 v27, v8, v28
    v_sub_f32 v26, v24, v28
    v_mul_f32 v27, s9, v27
    v_mul_f32 v26, s9, v26
    v_exp_f32 v27, v27
    v_exp_f32 v26, v26
    v_mov_b32 v8, v28
    v_fma_f32 v9, v9, v27, v26
    v_mul_f32 v10, v10, v27
    v_mul_f32 v11, v11, v27
    v_mul_f32 v12, v12, v27
    v_mul_f32 v13, v13, v27
    v_mul_f32 v14, v14, v27
    v_mul_f32 v15, v15, v27
    v_mul_f32 v16, v16, v27
    v_mul_f32 v17, v17, v27
    s_waitcnt vmcnt(16)
    v_lshlrev_b32 v18, 16, v148
    v_and_b32 v19, s10, v148
    v_lshlrev_b32 v20, 16, v149
    v_and_b32 v21, s10, v149
    v_lshlrev_b32 v22, 16, v150
    v_and_b32 v23, s10, v150
    v_lshlrev_b32 v24, 16, v151
    v_and_b32 v25, s10, v151
    v_fmac_f32_dpp v10, v26, v18 row_newbcast:0 row_mask:0xf bank_mask:0xf
    v_fmac_f32_dpp v11, v26, v19 row_newbcast:0 row_mask:0xf bank_mask:0xf
    v_fmac_f32_dpp v12, v26, v20 row_newbcast:0 row_mask:0xf bank_mask:0xf
    v_fmac_f32_dpp v13, v26, v21 row_newbcast:0 row_mask:0xf bank_mask:0xf
    v_fmac_f32_dpp v14, v26, v22 row_newbcast:0 row_mask:0xf bank_mask:0xf
    v_fmac_f32_dpp v15, v26, v23 row_newbcast:0 row_mask:0xf bank_mask:0xf
    v_fmac_f32_dpp v16, v26, v24 row_newbcast:0 row_mask:0xf bank_mask:0xf
    v_fmac_f32_dpp v17, v26, v25 row_newbcast:0 row_mask:0xf bank_mask:0xf
    v_lshlrev_b32 v18, 16, v152
    v_and_b32 v19, s10, v152
    v_lshlrev_b32 v20, 16, v153
    v_and_b32 v21, s10, v153
    v_lshlrev_b32 v22, 16, v154
    v_and_b32 v23, s10, v154
    v_lshlrev_b32 v24, 16, v155
    v_and_b32 v25, s10, v155
    v_fmac_f32_dpp v10, v26, v18 row_newbcast:4 row_mask:0xf bank_mask:0xf
    v_fmac_f32_dpp v11, v26, v19 row_newbcast:4 row_mask:0xf bank_mask:0xf
    v_fmac_f32_dpp v12, v26, v20 row_newbcast:4 row_mask:0xf bank_mask:0xf
    v_fmac_f32_dpp v13, v26, v21 row_newbcast:4 row_mask:0xf bank_mask:0xf
    v_fmac_f32_dpp v14, v26, v22 row_newbcast:4 row_mask:0xf bank_mask:0xf
    v_fmac_f32_dpp v15, v26, v23 row_newbcast:4 row_mask:0xf bank_mask:0xf
    v_fmac_f32_dpp v16, v26, v24 row_newbcast:4 row_mask:0xf bank_mask:0xf
    v_fmac_f32_dpp v17, v26, v25 row_newbcast:4 row_mask:0xf bank_mask:0xf
    v_lshlrev_b32 v18, 16, v156
    v_and_b32 v19, s10, v156
    v_lshlrev_b32 v20, 16, v157
    v_and_b32 v21, s10, v157
    v_lshlrev_b32 v22, 16, v158
    v_and_b32 v23, s10, v158
    v_lshlrev_b32 v24, 16, v159
    v_and_b32 v25, s10, v159
    v_fmac_f32_dpp v10, v26, v18 row_newbcast:8 row_mask:0xf bank_mask:0xf
    v_fmac_f32_dpp v11, v26, v19 row_newbcast:8 row_mask:0xf bank_mask:0xf
    v_fmac_f32_dpp v12, v26, v20 row_newbcast:8 row_mask:0xf bank_mask:0xf
    v_fmac_f32_dpp v13, v26, v21 row_newbcast:8 row_mask:0xf bank_mask:0xf
    v_fmac_f32_dpp v14, v26, v22 row_newbcast:8 row_mask:0xf bank_mask:0xf
    v_fmac_f32_dpp v15, v26, v23 row_newbcast:8 row_mask:0xf bank_mask:0xf
    v_fmac_f32_dpp v16, v26, v24 row_newbcast:8 row_mask:0xf bank_mask:0xf
    v_fmac_f32_dpp v17, v26, v25 row_newbcast:8 row_mask:0xf bank_mask:0xf
    v_lshlrev_b32 v18, 16, v160
    v_and_b32 v19, s10, v160
    v_lshlrev_b32 v20, 16, v161
    v_and_b32 v21, s10, v161
    v_lshlrev_b32 v22, 16, v162
    v_and_b32 v23, s10, v162
    v_lshlrev_b32 v24, 16, v163
    v_and_b32 v25, s10, v163
    v_fmac_f32_dpp v10, v26, v18 row_newbcast:12 row_mask:0xf bank_mask:0xf
    v_fmac_f32_dpp v11, v26, v19 row_newbcast:12 row_mask:0xf bank_mask:0xf
    v_fmac_f32_dpp v12, v26, v20 row_newbcast:12 row_mask:0xf bank_mask:0xf
    v_fmac_f32_dpp v13, v26, v21 row_newbcast:12 row_mask:0xf bank_mask:0xf
    v_fmac_f32_dpp v14, v26, v22 row_newbcast:12 row_mask:0xf bank_mask:0xf
    v_fmac_f32_dpp v15, v26, v23 row_newbcast:12 row_mask:0xf bank_mask:0xf
    v_fmac_f32_dpp v16, v26, v24 row_newbcast:12 row_mask:0xf bank_mask:0xf
    v_fmac_f32_dpp v17, v26, v25 row_newbcast:12 row_mask:0xf bank_mask:0xf
    v_lshrrev_b32 v22, 4, v1
    v_and_b32 v23, 1, v22
    v_lshlrev_b32 v23, 1, v23
    v_lshrrev_b32 v22, 1, v22
    v_or_b32 v22, v22, v23
    v_and_b32 v23, 15, v1
    v_lshl_add_u32 v22, v23, 3, v22
    v_lshlrev_b32 v22, 2, v22
    s_lshl_b32 s12, s3, 9
    v_add_u32 v124, s12, v22
    s_lshl_b32 s12, s3, 3
    v_mov_b32 v125, s12
    v_and_b32 v126, 7, v1
    v_lshlrev_b32 v126, 3, v126
    v_and_b32 v127, 31, v1
    v_lshlrev_b32 v127, 4, v127
    v_lshrrev_b32 v22, 5, v1
    v_lshl_add_u32 v127, v22, 11, v127
    v_lshlrev_b32 v128, 4, v1
    v_cmp_gt_u32 vcc, 33, v1
    v_mov_b32 v22, 0x40000000
    s_nop 0
    v_cndmask_b32 v128, v22, v128, vcc
    s_mov_b32 s16, s42
    s_and_b32 s17, s43, 0xffff
    s_mov_b32 s18, 0x400000
    s_mov_b32 s19, 0x20000
    s_lshl_b32 s59, s2, 10
    s_add_u32 s59, s59, 2097152
L_SLOOP:
    s_cmp_eq_u32 s52, 0
    s_cbranch_scc1 L_SDONE
    s_mov_b64 exec, 1
    ds_add_rtn_u32 v29, v3, v30 offset:11840
    s_mov_b64 exec, -1
    s_cmp_lg_u32 s57, 0
    s_cbranch_scc1 L_w1_11
    s_waitcnt vmcnt(12)
    s_branch L_w2_12
L_w1_11:
    s_waitcnt vmcnt(4)
L_w2_12:
    v_dot2_f32_bf16 v18, v36, v4, 0
    v_dot2_f32_bf16 v19, v40, v4, 0
    v_dot2_f32_bf16 v20, v44, v4, 0
    v_dot2_f32_bf16 v21, v48, v4, 0
    v_dot2_f32_bf16 v18, v37, v5, v18
    v_dot2_f32_bf16 v19, v41, v5, v19
    v_dot2_f32_bf16 v20, v45, v5, v20
    v_dot2_f32_bf16 v21, v49, v5, v21
    v_dot2_f32_bf16 v18, v38, v6, v18
    v_dot2_f32_bf16 v19, v42, v6, v19
    v_dot2_f32_bf16 v20, v46, v6, v20
    v_dot2_f32_bf16 v21, v50, v6, v21
    v_dot2_f32_bf16 v18, v39, v7, v18
    v_dot2_f32_bf16 v19, v43, v7, v19
    v_dot2_f32_bf16 v20, v47, v7, v20
    v_dot2_f32_bf16 v21, v51, v7, v21
    v_add_f32_dpp v22, v18, v18 row_ror:8 row_mask:0xf bank_mask:0x3
    v_add_f32_dpp v23, v19, v19 row_ror:8 row_mask:0xf bank_mask:0x3
    s_nop 0
    v_add_f32_dpp v22, v20, v20 row_ror:8 row_mask:0xf bank_mask:0xc
    s_nop 0
    v_add_f32_dpp v23, v21, v21 row_ror:8 row_mask:0xf bank_mask:0xc
    s_nop 0
    v_add_f32_dpp v24, v22, v22 row_half_mirror row_mask:0xf bank_mask:0x5
    s_nop 1
    v_add_f32_dpp v24, v23, v23 row_half_mirror row_mask:0xf bank_mask:0xa
    s_nop 1
    v_add_f32_dpp v24, v24, v24 quad_perm:[1,0,3,2] row_mask:0xf bank_mask:0xf
    s_nop 1
    v_add_f32_dpp v24, v24, v24 quad_perm:[2,3,0,1] row_mask:0xf bank_mask:0xf
    v_cvt_pk_bf16_f32 v24, v24, v24
    v_and_b32 v24, s10, v24
    v_mul_f32 v24, s8, v24
    v_cvt_pk_bf16_f32 v24, v24, v24
    v_and_b32 v24, s10, v24
    s_nop 1
    v_max_f32_dpp v22, v24, v24 row_ror:4 row_mask:0xf bank_mask:0xf
    s_nop 1
    v_max_f32_dpp v22, v22, v22 row_ror:8 row_mask:0xf bank_mask:0xf
    v_max_f32 v28, v8, v22
    v_sub_f32 v27, v8, v28
    v_sub_f32 v26, v24, v28
    v_mul_f32 v27, s9, v27
    v_mul_f32 v26, s9, v26
    v_exp_f32 v27, v27
    v_exp_f32 v26, v26
    v_mov_b32 v8, v28
    v_fma_f32 v9, v9, v27, v26
    v_mul_f32 v10, v10, v27
    v_mul_f32 v11, v11, v27
    v_mul_f32 v12, v12, v27
    v_mul_f32 v13, v13, v27
    v_mul_f32 v14, v14, v27
    v_mul_f32 v15, v15, v27
    v_mul_f32 v16, v16, v27
    v_mul_f32 v17, v17, v27
    s_cmp_lg_u32 s57, 0
    s_cbranch_scc1 L_w1_13
    s_waitcnt vmcnt(8)
    s_branch L_w2_14
L_w1_13:
    s_waitcnt vmcnt(0)
L_w2_14:
    v_lshlrev_b32 v18, 16, v52
    v_and_b32 v19, s10, v52
    v_lshlrev_b32 v20, 16, v53
    v_and_b32 v21, s10, v53
    v_lshlrev_b32 v22, 16, v54
    v_and_b32 v23, s10, v54
    v_lshlrev_b32 v24, 16, v55
    v_and_b32 v25, s10, v55
    v_fmac_f32_dpp v10, v26, v18 row_newbcast:0 row_mask:0xf bank_mask:0xf
    v_fmac_f32_dpp v11, v26, v19 row_newbcast:0 row_mask:0xf bank_mask:0xf
    v_fmac_f32_dpp v12, v26, v20 row_newbcast:0 row_mask:0xf bank_mask:0xf
    v_fmac_f32_dpp v13, v26, v21 row_newbcast:0 row_mask:0xf bank_mask:0xf
    v_fmac_f32_dpp v14, v26, v22 row_newbcast:0 row_mask:0xf bank_mask:0xf
    v_fmac_f32_dpp v15, v26, v23 row_newbcast:0 row_mask:0xf bank_mask:0xf
    v_fmac_f32_dpp v16, v26, v24 row_newbcast:0 row_mask:0xf bank_mask:0xf
    v_fmac_f32_dpp v17, v26, v25 row_newbcast:0 row_mask:0xf bank_mask:0xf
    v_lshlrev_b32 v18, 16, v56
    v_and_b32 v19, s10, v56
    v_lshlrev_b32 v20, 16, v57
    v_and_b32 v21, s10, v57
    v_lshlrev_b32 v22, 16, v58
    v_and_b32 v23, s10, v58
    v_lshlrev_b32 v24, 16, v59
    v_and_b32 v25, s10, v59
    v_fmac_f32_dpp v10, v26, v18 row_newbcast:4 row_mask:0xf bank_mask:0xf
    v_fmac_f32_dpp v11, v26, v19 row_newbcast:4 row_mask:0xf bank_mask:0xf
    v_fmac_f32_dpp v12, v26, v20 row_newbcast:4 row_mask:0xf bank_mask:0xf
    v_fmac_f32_dpp v13, v26, v21 row_newbcast:4 row_mask:0xf bank_mask:0xf
    v_fmac_f32_dpp v14, v26, v22 row_newbcast:4 row_mask:0xf bank_mask:0xf
    v_fmac_f32_dpp v15, v26, v23 row_newbcast:4 row_mask:0xf bank_mask:0xf
    v_fmac_f32_dpp v16, v26, v24 row_newbcast:4 row_mask:0xf bank_mask:0xf
    v_fmac_f32_dpp v17, v26, v25 row_newbcast:4 row_mask:0xf bank_mask:0xf
    v_lshlrev_b32 v18, 16, v60
    v_and_b32 v19, s10, v60
    v_lshlrev_b32 v20, 16, v61
    v_and_b32 v21, s10, v61
    v_lshlrev_b32 v22, 16, v62
    v_and_b32 v23, s10, v62
    v_lshlrev_b32 v24, 16, v63
    v_and_b32 v25, s10, v63
    v_fmac_f32_dpp v10, v26, v18 row_newbcast:8 row_mask:0xf bank_mask:0xf
    v_fmac_f32_dpp v11, v26, v19 row_newbcast:8 row_mask:0xf bank_mask:0xf
    v_fmac_f32_dpp v12, v26, v20 row_newbcast:8 row_mask:0xf bank_mask:0xf
    v_fmac_f32_dpp v13, v26, v21 row_newbcast:8 row_mask:0xf bank_mask:0xf
    v_fmac_f32_dpp v14, v26, v22 row_newbcast:8 row_mask:0xf bank_mask:0xf
    v_fmac_f32_dpp v15, v26, v23 row_newbcast:8 row_mask:0xf bank_mask:0xf
    v_fmac_f32_dpp v16, v26, v24 row_newbcast:8 row_mask:0xf bank_mask:0xf
    v_fmac_f32_dpp v17, v26, v25 row_newbcast:8 row_mask:0xf bank_mask:0xf
    v_lshlrev_b32 v18, 16, v64
    v_and_b32 v19, s10, v64
    v_lshlrev_b32 v20, 16, v65
    v_and_b32 v21, s10, v65
    v_lshlrev_b32 v22, 16, v66
    v_and_b32 v23, s10, v66
    v_lshlrev_b32 v24, 16, v67
    v_and_b32 v25, s10, v67
    v_fmac_f32_dpp v10, v26, v18 row_newbcast:12 row_mask:0xf bank_mask:0xf
    v_fmac_f32_dpp v11, v26, v19 row_newbcast:12 row_mask:0xf bank_mask:0xf
    v_fmac_f32_dpp v12, v26, v20 row_newbcast:12 row_mask:0xf bank_mask:0xf
    v_fmac_f32_dpp v13, v26, v21 row_newbcast:12 row_mask:0xf bank_mask:0xf
    v_fmac_f32_dpp v14, v26, v22 row_newbcast:12 row_mask:0xf bank_mask:0xf
    v_fmac_f32_dpp v15, v26, v23 row_newbcast:12 row_mask:0xf bank_mask:0xf
    v_fmac_f32_dpp v16, v26, v24 row_newbcast:12 row_mask:0xf bank_mask:0xf
    v_fmac_f32_dpp v17, v26, v25 row_newbcast:12 row_mask:0xf bank_mask:0xf
    s_waitcnt lgkmcnt(0)
    v_readfirstlane_b32 s12, v29
    s_nop 0
    s_cmp_ge_u32 s12, 160
    s_cbranch_scc1 L_mp_15
    s_lshl_b32 s7, s12, 12
    s_add_u32 s7, s7, s5
    s_mov_b32 s52, 1
    s_branch L_mgo_17
L_mp_15:
    s_sub_u32 s12, s12, 160
    s_lshl_b32 s12, s12, 2
    v_mov_b32 v25, s12
    s_mov_b32 s60, 0
L_msp_16:
    s_add_u32 s60, s60, 1
    s_cmp_gt_u32 s60, 12800000
    s_cbranch_scc1 L_mend_18
    ds_read_b32 v29, v25 offset:12288
    s_waitcnt lgkmcnt(0)
    v_readfirstlane_b32 s13, v29
    s_nop 0
    s_cmp_eq_u32 s13, -1
    s_cbranch_scc1 L_msp_16
    s_cmp_eq_u32 s13, -2
    s_cbranch_scc1 L_mend_18
    s_add_u32 s7, s13, s56
    s_mov_b32 s52, 1
    s_branch L_mgo_17
L_mend_18:
    s_mov_b32 s7, 0x40000000
    s_mov_b32 s52, 0
L_mgo_17:
    s_cmp_eq_u32 s52, 0
    s_cselect_b32 s57, 1, s57
    s_cbranch_scc1 L_noiss_19
    buffer_load_dwordx4 v[36:39], v2, s[44:47], s7 offen offset:0 nt
    buffer_load_dwordx4 v[40:43], v2, s[44:47], s7 offen offset:1024 nt
    buffer_load_dwordx4 v[44:47], v2, s[44:47], s7 offen offset:2048 nt
    buffer_load_dwordx4 v[48:51], v2, s[44:47], s7 offen offset:3072 nt
    buffer_load_dwordx4 v[52:55], v2, s[48:51], s7 offen offset:0 nt
    buffer_load_dwordx4 v[56:59], v2, s[48:51], s7 offen offset:1024 nt
    buffer_load_dwordx4 v[60:63], v2, s[48:51], s7 offen offset:2048 nt
    buffer_load_dwordx4 v[64:67], v2, s[48:51], s7 offen offset:3072 nt
L_noiss_19:
    s_cmp_eq_u32 s53, 0
    s_cbranch_scc1 L_SDONE
    s_mov_b64 exec, 1
    ds_add_rtn_u32 v29, v3, v30 offset:11840
    s_mov_b64 exec, -1
    s_cmp_lg_u32 s57, 0
    s_cbranch_scc1 L_w1_20
    s_waitcnt vmcnt(12)
    s_branch L_w2_21
L_w1_20:
    s_waitcnt vmcnt(4)
L_w2_21:
    v_dot2_f32_bf16 v18, v68, v4, 0
    v_dot2_f32_bf16 v19, v72, v4, 0
    v_dot2_f32_bf16 v20, v76, v4, 0
    v_dot2_f32_bf16 v21, v80, v4, 0
    v_dot2_f32_bf16 v18, v69, v5, v18
    v_dot2_f32_bf16 v19, v73, v5, v19
    v_dot2_f32_bf16 v20, v77, v5, v20
    v_dot2_f32_bf16 v21, v81, v5, v21
    v_dot2_f32_bf16 v18, v70, v6, v18
    v_dot2_f32_bf16 v19, v74, v6, v19
    v_dot2_f32_bf16 v20, v78, v6, v20
    v_dot2_f32_bf16 v21, v82, v6, v21
    v_dot2_f32_bf16 v18, v71, v7, v18
    v_dot2_f32_bf16 v19, v75, v7, v19
    v_dot2_f32_bf16 v20, v79, v7, v20
    v_dot2_f32_bf16 v21, v83, v7, v21
    v_add_f32_dpp v22, v18, v18 row_ror:8 row_mask:0xf bank_mask:0x3
    v_add_f32_dpp v23, v19, v19 row_ror:8 row_mask:0xf bank_mask:0x3
    s_nop 0
    v_add_f32_dpp v22, v20, v20 row_ror:8 row_mask:0xf bank_mask:0xc
    s_nop 0
    v_add_f32_dpp v23, v21, v21 row_ror:8 row_mask:0xf bank_mask:0xc
    s_nop 0
    v_add_f32_dpp v24, v22, v22 row_half_mirror row_mask:0xf bank_mask:0x5
    s_nop 1
    v_add_f32_dpp v24, v23, v23 row_half_mirror row_mask:0xf bank_mask:0xa
    s_nop 1
    v_add_f32_dpp v24, v24, v24 quad_perm:[1,0,3,2] row_mask:0xf bank_mask:0xf
    s_nop 1
    v_add_f32_dpp v24, v24, v24 quad_perm:[2,3,0,1] row_mask:0xf bank_mask:0xf
    v_cvt_pk_bf16_f32 v24, v24, v24
    v_and_b32 v24, s10, v24
    v_mul_f32 v24, s8, v24
    v_cvt_pk_bf16_f32 v24, v24, v24
    v_and_b32 v24, s10, v24
    s_nop 1
    v_max_f32_dpp v22, v24, v24 row_ror:4 row_mask:0xf bank_mask:0xf
    s_nop 1
    v_max_f32_dpp v22, v22, v22 row_ror:8 row_mask:0xf bank_mask:0xf
    v_max_f32 v28, v8, v22
    v_sub_f32 v27, v8, v28
    v_sub_f32 v26, v24, v28
    v_mul_f32 v27, s9, v27
    v_mul_f32 v26, s9, v26
    v_exp_f32 v27, v27
    v_exp_f32 v26, v26
    v_mov_b32 v8, v28
    v_fma_f32 v9, v9, v27, v26
    v_mul_f32 v10, v10, v27
    v_mul_f32 v11, v11, v27
    v_mul_f32 v12, v12, v27
    v_mul_f32 v13, v13, v27
    v_mul_f32 v14, v14, v27
    v_mul_f32 v15, v15, v27
    v_mul_f32 v16, v16, v27
    v_mul_f32 v17, v17, v27
    s_cmp_lg_u32 s57, 0
    s_cbranch_scc1 L_w1_22
    s_waitcnt vmcnt(8)
    s_branch L_w2_23
L_w1_22:
    s_waitcnt vmcnt(0)
L_w2_23:
    v_lshlrev_b32 v18, 16, v84
    v_and_b32 v19, s10, v84
    v_lshlrev_b32 v20, 16, v85
    v_and_b32 v21, s10, v85
    v_lshlrev_b32 v22, 16, v86
    v_and_b32 v23, s10, v86
    v_lshlrev_b32 v24, 16, v87
    v_and_b32 v25, s10, v87
    v_fmac_f32_dpp v10, v26, v18 row_newbcast:0 row_mask:0xf bank_mask:0xf
    v_fmac_f32_dpp v11, v26, v19 row_newbcast:0 row_mask:0xf bank_mask:0xf
    v_fmac_f32_dpp v12, v26, v20 row_newbcast:0 row_mask:0xf bank_mask:0xf
    v_fmac_f32_dpp v13, v26, v21 row_newbcast:0 row_mask:0xf bank_mask:0xf
    v_fmac_f32_dpp v14, v26, v22 row_newbcast:0 row_mask:0xf bank_mask:0xf
    v_fmac_f32_dpp v15, v26, v23 row_newbcast:0 row_mask:0xf bank_mask:0xf
    v_fmac_f32_dpp v16, v26, v24 row_newbcast:0 row_mask:0xf bank_mask:0xf
    v_fmac_f32_dpp v17, v26, v25 row_newbcast:0 row_mask:0xf bank_mask:0xf
    v_lshlrev_b32 v18, 16, v88
    v_and_b32 v19, s10, v88
    v_lshlrev_b32 v20, 16, v89
    v_and_b32 v21, s10, v89
    v_lshlrev_b32 v22, 16, v90
    v_and_b32 v23, s10, v90
    v_lshlrev_b32 v24, 16, v91
    v_and_b32 v25, s10, v91
    v_fmac_f32_dpp v10, v26, v18 row_newbcast:4 row_mask:0xf bank_mask:0xf
    v_fmac_f32_dpp v11, v26, v19 row_newbcast:4 row_mask:0xf bank_mask:0xf
    v_fmac_f32_dpp v12, v26, v20 row_newbcast:4 row_mask:0xf bank_mask:0xf
    v_fmac_f32_dpp v13, v26, v21 row_newbcast:4 row_mask:0xf bank_mask:0xf
    v_fmac_f32_dpp v14, v26, v22 row_newbcast:4 row_mask:0xf bank_mask:0xf
    v_fmac_f32_dpp v15, v26, v23 row_newbcast:4 row_mask:0xf bank_mask:0xf
    v_fmac_f32_dpp v16, v26, v24 row_newbcast:4 row_mask:0xf bank_mask:0xf
    v_fmac_f32_dpp v17, v26, v25 row_newbcast:4 row_mask:0xf bank_mask:0xf
    v_lshlrev_b32 v18, 16, v92
    v_and_b32 v19, s10, v92
    v_lshlrev_b32 v20, 16, v93
    v_and_b32 v21, s10, v93
    v_lshlrev_b32 v22, 16, v94
    v_and_b32 v23, s10, v94
    v_lshlrev_b32 v24, 16, v95
    v_and_b32 v25, s10, v95
    v_fmac_f32_dpp v10, v26, v18 row_newbcast:8 row_mask:0xf bank_mask:0xf
    v_fmac_f32_dpp v11, v26, v19 row_newbcast:8 row_mask:0xf bank_mask:0xf
    v_fmac_f32_dpp v12, v26, v20 row_newbcast:8 row_mask:0xf bank_mask:0xf
    v_fmac_f32_dpp v13, v26, v21 row_newbcast:8 row_mask:0xf bank_mask:0xf
    v_fmac_f32_dpp v14, v26, v22 row_newbcast:8 row_mask:0xf bank_mask:0xf
    v_fmac_f32_dpp v15, v26, v23 row_newbcast:8 row_mask:0xf bank_mask:0xf
    v_fmac_f32_dpp v16, v26, v24 row_newbcast:8 row_mask:0xf bank_mask:0xf
    v_fmac_f32_dpp v17, v26, v25 row_newbcast:8 row_mask:0xf bank_mask:0xf
    v_lshlrev_b32 v18, 16, v96
    v_and_b32 v19, s10, v96
    v_lshlrev_b32 v20, 16, v97
    v_and_b32 v21, s10, v97
    v_lshlrev_b32 v22, 16, v98
    v_and_b32 v23, s10, v98
    v_lshlrev_b32 v24, 16, v99
    v_and_b32 v25, s10, v99
    v_fmac_f32_dpp v10, v26, v18 row_newbcast:12 row_mask:0xf bank_mask:0xf
    v_fmac_f32_dpp v11, v26, v19 row_newbcast:12 row_mask:0xf bank_mask:0xf
    v_fmac_f32_dpp v12, v26, v20 row_newbcast:12 row_mask:0xf bank_mask:0xf
    v_fmac_f32_dpp v13, v26, v21 row_newbcast:12 row_mask:0xf bank_mask:0xf
    v_fmac_f32_dpp v14, v26, v22 row_newbcast:12 row_mask:0xf bank_mask:0xf
    v_fmac_f32_dpp v15, v26, v23 row_newbcast:12 row_mask:0xf bank_mask:0xf
    v_fmac_f32_dpp v16, v26, v24 row_newbcast:12 row_mask:0xf bank_mask:0xf
    v_fmac_f32_dpp v17, v26, v25 row_newbcast:12 row_mask:0xf bank_mask:0xf
    s_waitcnt lgkmcnt(0)
    v_readfirstlane_b32 s12, v29
    s_nop 0
    s_cmp_ge_u32 s12, 160
    s_cbranch_scc1 L_mp_24
    s_lshl_b32 s7, s12, 12
    s_add_u32 s7, s7, s5
    s_mov_b32 s53, 1
    s_branch L_mgo_26
L_mp_24:
    s_sub_u32 s12, s12, 160
    s_lshl_b32 s12, s12, 2
    v_mov_b32 v25, s12
    s_mov_b32 s60, 0
L_msp_25:
    s_add_u32 s60, s60, 1
    s_cmp_gt_u32 s60, 12800000
    s_cbranch_scc1 L_mend_27
    ds_read_b32 v29, v25 offset:12288
    s_waitcnt lgkmcnt(0)
    v_readfirstlane_b32 s13, v29
    s_nop 0
    s_cmp_eq_u32 s13, -1
    s_cbranch_scc1 L_msp_25
    s_cmp_eq_u32 s13, -2
    s_cbranch_scc1 L_mend_27
    s_add_u32 s7, s13, s56
    s_mov_b32 s53, 1
    s_branch L_mgo_26
L_mend_27:
    s_mov_b32 s7, 0x40000000
    s_mov_b32 s53, 0
L_mgo_26:
    s_cmp_eq_u32 s53, 0
    s_cselect_b32 s57, 1, s57
    s_cbranch_scc1 L_noiss_28
    buffer_load_dwordx4 v[68:71], v2, s[44:47], s7 offen offset:0 nt
    buffer_load_dwordx4 v[72:75], v2, s[44:47], s7 offen offset:1024 nt
    buffer_load_dwordx4 v[76:79], v2, s[44:47], s7 offen offset:2048 nt
    buffer_load_dwordx4 v[80:83], v2, s[44:47], s7 offen offset:3072 nt
    buffer_load_dwordx4 v[84:87], v2, s[48:51], s7 offen offset:0 nt
    buffer_load_dwordx4 v[88:91], v2, s[48:51], s7 offen offset:1024 nt
    buffer_load_dwordx4 v[92:95], v2, s[48:51], s7 offen offset:2048 nt
    buffer_load_dwordx4 v[96:99], v2, s[48:51], s7 offen offset:3072 nt
L_noiss_28:
    s_branch L_SLOOP
L_SDONE:
    v_mov_b32 v22, v8
    v_mov_b32 v23, v8
    s_nop 1
    v_permlane16_swap_b32 v22, v23
    v_max_f32 v22, v22, v23
    v_mov_b32 v23, v22
    s_nop 1
    v_permlane32_swap_b32 v22, v23
    v_max_f32 v28, v22, v23
    v_sub_f32 v27, v8, v28
    v_mul_f32 v27, s9, v27
    v_exp_f32 v27, v27
    s_nop 0
    v_mul_f32 v9, v9, v27
    v_mul_f32 v10, v10, v27
    v_mul_f32 v11, v11, v27
    v_mul_f32 v12, v12, v27
    v_mul_f32 v13, v13, v27
    v_mul_f32 v14, v14, v27
    v_mul_f32 v15, v15, v27
    v_mul_f32 v16, v16, v27
    v_mul_f32 v17, v17, v27
    v_add_f32_dpp v9, v9, v9 row_ror:4 row_mask:0xf bank_mask:0xf
    s_nop 1
    v_add_f32_dpp v9, v9, v9 row_ror:8 row_mask:0xf bank_mask:0xf
    v_mov_b32 v23, v9
    s_nop 1
    v_permlane16_swap_b32 v9, v23
    v_add_f32 v9, v9, v23
    v_mov_b32 v23, v9
    s_nop 1
    v_permlane32_swap_b32 v9, v23
    v_add_f32 v9, v9, v23
    v_permlane32_swap_b32 v10, v11
    v_permlane32_swap_b32 v12, v13
    v_permlane32_swap_b32 v14, v15
    v_permlane32_swap_b32 v16, v17
    v_add_f32 v10, v10, v11
    v_add_f32 v12, v12, v13
    v_add_f32 v14, v14, v15
    v_add_f32 v16, v16, v17
    v_permlane16_swap_b32 v10, v12
    s_nop 0
    v_permlane16_swap_b32 v14, v16
    v_add_f32 v10, v10, v12
    v_add_f32 v14, v14, v16
    ds_write_b32 v124, v10 offset:7680
    ds_write_b32 v124, v14 offset:7696
    v_mov_b32 v18, v28
    v_mov_b32 v19, v9
    ds_write_b64 v125, v[18:19] offset:11776
    s_mov_b64 exec, 1
    ds_add_rtn_u32 v29, v3, v30 offset:11848
    s_mov_b64 exec, -1
    s_waitcnt lgkmcnt(0)
    v_readfirstlane_b32 s12, v29
    s_nop 0
    s_cmp_lg_u32 s12, 7
    s_cbranch_scc1 L_SEND
    ds_read_b64 v[116:117], v126 offset:11776
    ds_read_b128 v[100:103], v127 offset:7680
    ds_read_b128 v[104:107], v127 offset:8192
    ds_read_b128 v[108:111], v127 offset:8704
    ds_read_b128 v[112:115], v127 offset:9216
    s_setprio 3
    v_cmp_gt_u32 vcc, 32, v1
    s_nop 0
    s_mov_b64 s[14:15], vcc
    s_waitcnt lgkmcnt(4)
    v_max_f32_dpp v118, v116, v116 quad_perm:[1,0,3,2] row_mask:0xf bank_mask:0xf
    s_nop 1
    v_max_f32_dpp v118, v118, v118 quad_perm:[2,3,0,1] row_mask:0xf bank_mask:0xf
    s_nop 1
    v_max_f32_dpp v118, v118, v118 row_half_mirror row_mask:0xf bank_mask:0xf
    v_sub_f32 v120, v116, v118
    v_mul_f32 v120, s9, v120
    v_exp_f32 v120, v120
    s_nop 0
    v_mul_f32 v119, v120, v117
    s_nop 0
    v_mov_b32_dpp v116, v120 row_newbcast:0 row_mask:0x3 bank_mask:0xf
    v_mov_b32_dpp v117, v120 row_newbcast:1 row_mask:0x3 bank_mask:0xf
    v_mov_b32_dpp v121, v120 row_newbcast:2 row_mask:0x3 bank_mask:0xf
    v_mov_b32_dpp v122, v120 row_newbcast:3 row_mask:0x3 bank_mask:0xf
    v_add_f32_dpp v119, v119, v119 quad_perm:[1,0,3,2] row_mask:0xf bank_mask:0xf
    v_mov_b32_dpp v116, v120 row_newbcast:4 row_mask:0xc bank_mask:0xf
    v_mov_b32_dpp v117, v120 row_newbcast:5 row_mask:0xc bank_mask:0xf
    v_mov_b32_dpp v121, v120 row_newbcast:6 row_mask:0xc bank_mask:0xf
    v_mov_b32_dpp v122, v120 row_newbcast:7 row_mask:0xc bank_mask:0xf
    v_add_f32_dpp v119, v119, v119 quad_perm:[2,3,0,1] row_mask:0xf bank_mask:0xf
    s_waitcnt lgkmcnt(0)
    v_mul_f32 v100, v100, v116
    v_mul_f32 v101, v101, v116
    v_mul_f32 v102, v102, v116
    v_mul_f32 v103, v103, v116
    v_add_f32_dpp v119, v119, v119 row_half_mirror row_mask:0xf bank_mask:0xf
    v_fma_f32 v100, v104, v117, v100
    v_fma_f32 v101, v105, v117, v101
    v_fma_f32 v102, v106, v117, v102
    v_fma_f32 v103, v107, v117, v103
    v_fma_f32 v100, v108, v121, v100
    v_fma_f32 v101, v109, v121, v101
    v_fma_f32 v102, v110, v121, v102
    v_fma_f32 v103, v111, v121, v103
    v_fma_f32 v100, v112, v122, v100
    v_fma_f32 v101, v113, v122, v101
    v_fma_f32 v102, v114, v122, v102
    v_fma_f32 v103, v115, v122, v103
    v_mov_b32 v104, v100
    v_mov_b32 v105, v101
    v_mov_b32 v106, v102
    v_mov_b32 v107, v103
    v_permlane32_swap_b32 v100, v104
    v_permlane32_swap_b32 v101, v105
    v_permlane32_swap_b32 v102, v106
    v_permlane32_swap_b32 v103, v107
    v_add_f32 v100, v100, v104
    v_add_f32 v101, v101, v105
    v_add_f32 v102, v102, v106
    v_add_f32 v103, v103, v107
    v_cndmask_b32 v100, v118, v100, s[14:15]
    v_cndmask_b32 v101, v119, v101, s[14:15]
    buffer_store_dwordx4 v[100:103], v128, s[16:19], s59 offen sc1
L_SEND:
    s_endpgm
L_CW:
    s_sub_u32 s3, s3, 8
    s_setprio 3
    v_mov_b32 v36, -1
    v_mov_b32 v37, -1
    v_mov_b32 v38, -1
    v_mov_b32 v39, -1
    v_mov_b32 v2, 0
    v_lshlrev_b32 v30, 4, v1
    s_lshl_b32 s7, s3, 10
    v_add_u32 v31, s7, v30
    ds_write_b128 v31, v[36:39] offset:2304
    s_lshl_b32 s7, s3, 11
    v_add_u32 v31, s7, v30
    ds_write_b128 v31, v[36:39] offset:12288
    ds_write_b128 v31, v[36:39] offset:13312
    ds_write_b32 v2, v2 offset:11844
    ds_write_b32 v2, v2 offset:11848
    ds_write_b32 v2, v2 offset:11852
    ds_write_b32 v2, v2 offset:11856
    ds_write_b32 v2, v2 offset:11860
    ds_write_b32 v2, v2 offset:11864
    s_lshr_b32 s5, s2, 3
    s_and_b32 s7, s2, 7
    s_lshr_b32 s8, s2, 6
    s_add_u32 s9, s7, s5
    s_and_b32 s9, s9, 7
    s_mov_b32 s4, 0
    s_mov_b32 s97, 0
    s_mov_b32 s98, 0
    s_cmp_ge_u32 s9, 2
    s_cbranch_scc1 L_p1_29
    s_mov_b32 s4, 2
    s_lshl_b32 s97, s5, 1
    s_add_u32 s97, s97, s9
    s_mov_b32 s98, 1
    s_branch L_pd_31
L_p1_29:
    s_cmp_eq_u32 s9, 2
    s_cbranch_scc0 L_p2_30
    s_mov_b32 s4, 1
    s_mov_b32 s97, s5
    s_cmp_lt_u32 s5, 20
    s_cselect_b32 s98, 1, 0
    s_branch L_pd_31
L_p2_30:
    s_cmp_eq_u32 s9, 3
    s_cbranch_scc0 L_pd_31
    s_cmp_lt_u32 s5, 28
    s_cbranch_scc0 L_pd_31
    s_mov_b32 s4, 1
    s_add_u32 s97, s5, 32
L_pd_31:
    s_mov_b32 s8, 32
    v_mov_b32 v31, s8
    ds_write_b32 v2, v31 offset:11840
    s_lshr_b32 s8, s2, 6
    s_mov_b32 s10, 3
    s_mov_b32 s11, 0
    s_mov_b32 s12, 0
    s_cmp_ge_u32 s9, 5
    s_cbranch_scc1 L_rm_32
    s_mov_b32 s11, s7
    s_mul_i32 s12, s8, 5
    s_add_u32 s12, s12, s9
    s_mov_b32 s10, 0
    s_branch L_rd_34
L_rm_32:
    s_lshl_b32 s7, s7, 2
    s_add_u32 s7, s7, s8
    s_cmp_eq_u32 s9, 7
    s_cbranch_scc1 L_rf_33
    s_cmp_ge_u32 s7, 27
    s_cbranch_scc1 L_rd_34
    s_lshl_b32 s7, s7, 1
    s_sub_u32 s9, s9, 5
    s_add_u32 s11, s7, s9
    s_mov_b32 s10, 1
    s_branch L_rd_34
L_rf_33:
    s_cmp_ge_u32 s7, 20
    s_cbranch_scc1 L_rd_34
    s_mov_b32 s11, s7
    s_mov_b32 s10, 2
L_rd_34:
    v_lshrrev_b32 v3, 4, v1
    v_and_b32 v32, 15, v1
    v_lshrrev_b32 v33, 2, v32
    v_and_b32 v34, 3, v32
    v_lshl_add_u32 v33, v3, 3, v33
    v_lshlrev_b32 v34, 3, v34
    v_lshl_add_u32 v4, v33, 5, v34
    v_lshl_add_u32 v5, v33, 6, v34
    v_lshl_add_u32 v15, v33, 7, v34
    v_lshlrev_b32 v3, 4, v3
    s_mul_i32 s7, s3, 160
    v_lshl_add_u32 v7, v1, 2, s7
    v_cmp_gt_u32 vcc, 40, v1
    s_nop 0
    s_mov_b64 s[14:15], vcc
    v_lshlrev_b32 v33, 1, v7
    v_mov_b32 v35, 0x40000000
    v_cndmask_b32 v6, v35, v33, s[14:15]
    s_lshl_b32 s7, s3, 9
    v_lshl_add_u32 v12, v1, 3, s7
    v_add_u32 v13, s7, v3
    v_lshlrev_b32 v33, 2, v7
    v_mov_b32 v35, 0x40000000
    v_cndmask_b32 v14, v35, v33, s[14:15]
    s_mov_b32 s13, 0xffff0000
    s_waitcnt lgkmcnt(0)
    s_barrier
    s_mov_b32 s44, s42
    s_and_b32 s45, s43, 0xffff
    s_mov_b32 s46, 0x400000
    s_mov_b32 s47, 0x20000
    s_mov_b32 s48, s40
    s_and_b32 s49, s41, 0xffff
    s_mov_b32 s50, 0x100
    s_mov_b32 s51, 0x20000
    buffer_load_dword v16, v2, s[44:47], 0 offen sc1
    s_mov_b32 s60, s16
    s_and_b32 s61, s17, 0xffff
    s_mov_b32 s62, 0x500
    s_mov_b32 s63, 0x20000
    buffer_load_dwordx2 v[26:27], v6, s[60:63], 0 offen
    s_cmp_eq_u32 s4, 1
    s_cbranch_scc1 L_PMOD
    s_cmp_eq_u32 s4, 2
    s_cbranch_scc1 L_PQ
    s_barrier
    s_waitcnt vmcnt(0)
    v_readfirstlane_b32 s6, v16
    s_nop 0
    s_mul_i32 s6, s6, 0x9E3779B1
    s_add_u32 s6, s6, 0x7F4A7C15
    v_lshlrev_b32 v8, 16, v26
    v_and_b32 v9, s13, v26
    v_lshlrev_b32 v10, 16, v27
    v_and_b32 v11, s13, v27
    s_cmp_eq_u32 s3, 0
    s_cbranch_scc1 L_nclr_35
    v_mov_b32 v36, -1
    v_mov_b32 v37, -1
    v_mov_b32 v38, -1
    v_mov_b32 v39, -1
    v_lshlrev_b32 v30, 4, v1
    s_cmp_eq_u32 s3, 3
    s_cbranch_scc0 L_ca1_36
    s_lshl_b32 s7, s2, 10
    s_add_u32 s7, s7, 2097152
    v_cmp_gt_u32 vcc, 33, v1
    v_mov_b32 v35, 0x40000000
    s_nop 0
    v_cndmask_b32 v31, v35, v30, vcc
    buffer_store_dwordx4 v[36:39], v31, s[44:47], s7 offen sc1
    s_branch L_cad_37
L_ca1_36:
    s_cmp_eq_u32 s3, 1
    s_cbranch_scc0 L_cad_37
    s_cmp_eq_u32 s10, 0
    s_cbranch_scc0 L_cad_37
    s_mul_i32 s7, s11, 2560
    s_lshl_b32 s8, s12, 7
    s_add_u32 s7, s7, s8
    s_add_u32 s7, s7, 393216
    v_lshrrev_b32 v32, 3, v1
    s_mov_b32 s9, 20480
    v_mul_lo_u32 v31, v32, s9
    v_and_b32 v34, 7, v1
    v_lshl_add_u32 v31, v34, 4, v31
    v_cmp_gt_u32 vcc, 1, v32
    v_mov_b32 v35, 0x40000000
    s_nop 0
    v_cndmask_b32 v31, v35, v31, vcc
    buffer_store_dwordx4 v[36:39], v31, s[44:47], s7 offen sc1
L_cad_37:
    s_mul_i32 s7, s11, 2560
    s_sub_u32 s8, s3, 1
    s_lshl_b32 s8, s8, 10
    s_add_u32 s7, s7, s8
    s_add_u32 s7, s7, 589824
    s_cmp_eq_u32 s3, 3
    s_cselect_b32 s8, 32, 64
    s_cmp_eq_u32 s10, 1
    s_cselect_b32 s8, s8, 0
    v_cmp_gt_u32 vcc, s8, v1
    v_mov_b32 v35, 0x40000000
    s_nop 0
    v_cndmask_b32 v31, v35, v30, vcc
    buffer_store_dwordx4 v[36:39], v31, s[44:47], s7 offen sc1
    s_and_b32 s7, s2, 7
    s_cmp_eq_u32 s7, 0
    s_cselect_b32 s8, 1, 0
    s_cmp_eq_u32 s3, 2
    s_cselect_b32 s8, s8, 0
    s_mul_i32 s7, s5, 256
    s_add_u32 s7, s7, 1966080
    v_cmp_gt_u32 vcc, s8, v1
    v_mov_b32 v35, 0x40000000
    s_nop 0
    v_cndmask_b32 v31, v35, v2, vcc
    buffer_store_dword v2, v31, s[44:47], s7 offen sc1
    s_waitcnt vmcnt(0)
    v_mov_b32 v34, 1
    s_mov_b64 exec, 1
    ds_add_rtn_u32 v33, v2, v34 offset:11852
    s_mov_b64 exec, -1
    s_waitcnt lgkmcnt(0)
    v_readfirstlane_b32 s7, v33
    s_nop 0
    s_cmp_lg_u32 s7, 2
    s_cbranch_scc1 L_nclr_35
    v_cmp_eq_u32 vcc, 0, v1
    v_mov_b32 v35, 0x40000000
    s_nop 0
    v_cndmask_b32 v33, v35, v2, vcc
    buffer_atomic_add v34, v33, s[48:51], 0 offen
L_nclr_35:
    s_branch L_PJOIN
L_PMOD:
    s_mov_b32 s52, s36
    s_and_b32 s53, s37, 0xffff
    s_mov_b32 s54, 0x4b0000
    s_mov_b32 s55, 0x20000
    s_mov_b32 s56, s34
    s_and_b32 s57, s35, 0xffff
    s_mov_b32 s58, 0x500
    s_mov_b32 s59, 0x20000
    buffer_load_dwordx2 v[18:19], v6, s[56:59], 0 offen
    v_lshrrev_b32 v32, 3, v1
    v_and_b32 v33, 7, v1
    v_lshlrev_b32 v33, 4, v33
    s_mov_b32 s7, 7680
    v_mul_lo_u32 v28, v32, s7
    v_add_u32 v28, v28, v33
    s_mul_i32 s7, s3, 1228800
    s_lshl_b32 s8, s97, 7
    s_add_u32 s7, s7, s8
    s_mul_i32 s9, s3, 30720
    s_add_u32 m0, s9, 20480
    s_nop 0
    buffer_load_dwordx4 v28, s[52:55], s7 offen nt lds
    s_add_u32 s7, s7, 61440
    s_add_u32 m0, s9, 21504
    s_nop 0
    buffer_load_dwordx4 v28, s[52:55], s7 offen nt lds
    s_add_u32 s7, s7, 61440
    s_add_u32 m0, s9, 22528
    s_nop 0
    buffer_load_dwordx4 v28, s[52:55], s7 offen nt lds
    s_add_u32 s7, s7, 61440
    s_add_u32 m0, s9, 23552
    s_nop 0
    buffer_load_dwordx4 v28, s[52:55], s7 offen nt lds
    s_add_u32 s7, s7, 61440
    s_add_u32 m0, s9, 24576
    s_nop 0
    buffer_load_dwordx4 v28, s[52:55], s7 offen nt lds
    s_add_u32 s7, s7, 61440
    s_add_u32 m0, s9, 25600
    s_nop 0
    buffer_load_dwordx4 v28, s[52:55], s7 offen nt lds
    s_add_u32 s7, s7, 61440
    s_add_u32 m0, s9, 26624
    s_nop 0
    buffer_load_dwordx4 v28, s[52:55], s7 offen nt lds
    s_add_u32 s7, s7, 61440
    s_add_u32 m0, s9, 27648
    s_nop 0
    buffer_load_dwordx4 v28, s[52:55], s7 offen nt lds
    s_add_u32 s7, s7, 61440
    s_add_u32 m0, s9, 28672
    s_nop 0
    buffer_load_dwordx4 v28, s[52:55], s7 offen nt lds
    s_add_u32 s7, s7, 61440
    s_add_u32 m0, s9, 29696
    s_nop 0
    buffer_load_dwordx4 v28, s[52:55], s7 offen nt lds
    s_add_u32 s7, s7, 61440
    s_add_u32 m0, s9, 30720
    s_nop 0
    buffer_load_dwordx4 v28, s[52:55], s7 offen nt lds
    s_add_u32 s7, s7, 61440
    s_add_u32 m0, s9, 31744
    s_nop 0
    buffer_load_dwordx4 v28, s[52:55], s7 offen nt lds
    s_add_u32 s7, s7, 61440
    s_add_u32 m0, s9, 32768
    s_nop 0
    buffer_load_dwordx4 v28, s[52:55], s7 offen nt lds
    s_add_u32 s7, s7, 61440
    s_add_u32 m0, s9, 33792
    s_nop 0
    buffer_load_dwordx4 v28, s[52:55], s7 offen nt lds
    s_add_u32 s7, s7, 61440
    s_add_u32 m0, s9, 34816
    s_nop 0
    buffer_load_dwordx4 v28, s[52:55], s7 offen nt lds
    s_add_u32 s7, s7, 61440
    s_add_u32 m0, s9, 35840
    s_nop 0
    buffer_load_dwordx4 v28, s[52:55], s7 offen nt lds
    s_add_u32 s7, s7, 61440
    s_add_u32 m0, s9, 36864
    s_nop 0
    buffer_load_dwordx4 v28, s[52:55], s7 offen nt lds
    s_add_u32 s7, s7, 61440
    s_add_u32 m0, s9, 37888
    s_nop 0
    buffer_load_dwordx4 v28, s[52:55], s7 offen nt lds
    s_add_u32 s7, s7, 61440
    s_add_u32 m0, s9, 38912
    s_nop 0
    buffer_load_dwordx4 v28, s[52:55], s7 offen nt lds
    s_add_u32 s7, s7, 61440
    s_add_u32 m0, s9, 39936
    s_nop 0
    buffer_load_dwordx4 v28, s[52:55], s7 offen nt lds
    s_cmp_lg_u32 s98, 0
    s_cbranch_scc1 L_b0b_38
    s_barrier
L_b0b_38:
    s_waitcnt vmcnt(20)
    v_readfirstlane_b32 s6, v16
    s_nop 0
    s_mul_i32 s6, s6, 0x9E3779B1
    s_add_u32 s6, s6, 0x7F4A7C15
    v_lshlrev_b32 v8, 16, v26
    v_and_b32 v9, s13, v26
    v_lshlrev_b32 v10, 16, v27
    v_and_b32 v11, s13, v27
    v_lshlrev_b32 v28, 16, v18
    v_and_b32 v29, s13, v18
    v_lshlrev_b32 v30, 16, v19
    v_and_b32 v31, s13, v19
    v_mul_f32 v32, 0xbfb8aa00, v28
    v_mul_f32 v33, 0xbfb8aa00, v29
    v_mul_f32 v34, 0xbfb8aa00, v30
    v_mul_f32 v35, 0xbfb8aa00, v31
    v_min_f32 v32, 0x42fc0000, v32
    v_min_f32 v33, 0x42fc0000, v33
    v_min_f32 v34, 0x42fc0000, v34
    v_min_f32 v35, 0x42fc0000, v35
    v_exp_f32 v32, v32
    v_exp_f32 v33, v33
    v_exp_f32 v34, v34
    v_exp_f32 v35, v35
    v_mul_f32 v40, 0xb6a407db, v28
    v_mul_f32 v41, 0xb6a407db, v29
    v_mul_f32 v42, 0xb6a407db, v30
    v_mul_f32 v43, 0xb6a407db, v31
    v_fma_f32 v32, v32, v40, v32
    v_fma_f32 v33, v33, v41, v33
    v_fma_f32 v34, v34, v42, v34
    v_fma_f32 v35, v35, v43, v35
    v_add_f32 v32, 1.0, v32
    v_add_f32 v33, 1.0, v33
    v_add_f32 v34, 1.0, v34
    v_add_f32 v35, 1.0, v35
    v_rcp_f32 v40, v32
    v_rcp_f32 v41, v33
    v_rcp_f32 v42, v34
    v_rcp_f32 v43, v35
    v_mul_f32 v44, v28, v40
    v_mul_f32 v45, v29, v41
    v_mul_f32 v46, v30, v42
    v_mul_f32 v47, v31, v43
    v_fma_f32 v48, -v44, v32, v28
    v_fma_f32 v49, -v45, v33, v29
    v_fma_f32 v50, -v46, v34, v30
    v_fma_f32 v51, -v47, v35, v31
    v_fma_f32 v28, v48, v40, v44
    v_fma_f32 v29, v49, v41, v45
    v_fma_f32 v30, v50, v42, v46
    v_fma_f32 v31, v51, v43, v47
    v_cvt_pk_bf16_f32 v28, v28, v29
    v_cvt_pk_bf16_f32 v29, v30, v31
    ds_write_b64 v12, v[28:29] offset:256
    ds_read_b128 v[120:123], v13 offset:256
    ds_read_b128 v[124:127], v13 offset:320
    ds_read_b128 v[128:131], v13 offset:384
    ds_read_b128 v[132:135], v13 offset:448
    ds_read_b128 v[136:139], v13 offset:512
    s_waitcnt vmcnt(0)
    s_mul_i32 s7, s3, 30720
    v_add_u32 v32, s7, v15
    ds_read_b64_tr_b16 v[40:41], v32 offset:20480
    ds_read_b64_tr_b16 v[42:43], v32 offset:20992
    ds_read_b64_tr_b16 v[60:61], v32 offset:20512
    ds_read_b64_tr_b16 v[62:63], v32 offset:21024
    ds_read_b64_tr_b16 v[80:81], v32 offset:20544
    ds_read_b64_tr_b16 v[82:83], v32 offset:21056
    ds_read_b64_tr_b16 v[100:101], v32 offset:20576
    ds_read_b64_tr_b16 v[102:103], v32 offset:21088
    ds_read_b64_tr_b16 v[44:45], v32 offset:24576
    ds_read_b64_tr_b16 v[46:47], v32 offset:25088
    ds_read_b64_tr_b16 v[64:65], v32 offset:24608
    ds_read_b64_tr_b16 v[66:67], v32 offset:25120
    ds_read_b64_tr_b16 v[84:85], v32 offset:24640
    ds_read_b64_tr_b16 v[86:87], v32 offset:25152
    ds_read_b64_tr_b16 v[104:105], v32 offset:24672
    ds_read_b64_tr_b16 v[106:107], v32 offset:25184
    s_waitcnt lgkmcnt(0)
    ds_read_b64_tr_b16 v[48:49], v32 offset:28672
    ds_read_b64_tr_b16 v[50:51], v32 offset:29184
    ds_read_b64_tr_b16 v[68:69], v32 offset:28704
    ds_read_b64_tr_b16 v[70:71], v32 offset:29216
    ds_read_b64_tr_b16 v[88:89], v32 offset:28736
    ds_read_b64_tr_b16 v[90:91], v32 offset:29248
    ds_read_b64_tr_b16 v[108:109], v32 offset:28768
    ds_read_b64_tr_b16 v[110:111], v32 offset:29280
    ds_read_b64_tr_b16 v[52:53], v32 offset:32768
    ds_read_b64_tr_b16 v[54:55], v32 offset:33280
    ds_read_b64_tr_b16 v[72:73], v32 offset:32800
    ds_read_b64_tr_b16 v[74:75], v32 offset:33312
    ds_read_b64_tr_b16 v[92:93], v32 offset:32832
    ds_read_b64_tr_b16 v[94:95], v32 offset:33344
    ds_read_b64_tr_b16 v[112:113], v32 offset:32864
    ds_read_b64_tr_b16 v[114:115], v32 offset:33376
    s_waitcnt lgkmcnt(0)
    ds_read_b64_tr_b16 v[56:57], v32 offset:36864
    ds_read_b64_tr_b16 v[58:59], v32 offset:37376
    ds_read_b64_tr_b16 v[76:77], v32 offset:36896
    ds_read_b64_tr_b16 v[78:79], v32 offset:37408
    ds_read_b64_tr_b16 v[96:97], v32 offset:36928
    ds_read_b64_tr_b16 v[98:99], v32 offset:37440
    ds_read_b64_tr_b16 v[116:117], v32 offset:36960
    ds_read_b64_tr_b16 v[118:119], v32 offset:37472
    s_waitcnt lgkmcnt(0)
    v_mfma_f32_16x16x32_bf16 v[140:143], v[40:43], v[120:123], 0
    v_mfma_f32_16x16x32_bf16 v[144:147], v[60:63], v[120:123], 0
    v_mfma_f32_16x16x32_bf16 v[148:151], v[80:83], v[120:123], 0
    v_mfma_f32_16x16x32_bf16 v[152:155], v[100:103], v[120:123], 0
    v_mfma_f32_16x16x32_bf16 v[140:143], v[44:47], v[124:127], v[140:143]
    v_mfma_f32_16x16x32_bf16 v[144:147], v[64:67], v[124:127], v[144:147]
    v_mfma_f32_16x16x32_bf16 v[148:151], v[84:87], v[124:127], v[148:151]
    v_mfma_f32_16x16x32_bf16 v[152:155], v[104:107], v[124:127], v[152:155]
    v_mfma_f32_16x16x32_bf16 v[140:143], v[48:51], v[128:131], v[140:143]
    v_mfma_f32_16x16x32_bf16 v[144:147], v[68:71], v[128:131], v[144:147]
    v_mfma_f32_16x16x32_bf16 v[148:151], v[88:91], v[128:131], v[148:151]
    v_mfma_f32_16x16x32_bf16 v[152:155], v[108:111], v[128:131], v[152:155]
    v_mfma_f32_16x16x32_bf16 v[140:143], v[52:55], v[132:135], v[140:143]
    v_mfma_f32_16x16x32_bf16 v[144:147], v[72:75], v[132:135], v[144:147]
    v_mfma_f32_16x16x32_bf16 v[148:151], v[92:95], v[132:135], v[148:151]
    v_mfma_f32_16x16x32_bf16 v[152:155], v[112:115], v[132:135], v[152:155]
    v_mfma_f32_16x16x32_bf16 v[140:143], v[56:59], v[136:139], v[140:143]
    v_mfma_f32_16x16x32_bf16 v[144:147], v[76:79], v[136:139], v[144:147]
    v_mfma_f32_16x16x32_bf16 v[148:151], v[96:99], v[136:139], v[148:151]
    v_mfma_f32_16x16x32_bf16 v[152:155], v[116:119], v[136:139], v[152:155]
    s_mul_i32 s7, s3, 256
    v_add_u32 v33, s7, v3
    s_mov_b32 exec_lo, 0x00010001
    s_mov_b32 exec_hi, 0x00010001
    s_nop 0
    ds_write_b128 v33, v[140:143] offset:2304
    s_nop 0
    ds_write_b128 v33, v[144:147] offset:2368
    s_nop 0
    ds_write_b128 v33, v[148:151] offset:2432
    s_nop 0
    ds_write_b128 v33, v[152:155] offset:2496
    s_mov_b64 exec, -1
    s_cmp_lg_u32 s3, 0
    s_cbranch_scc1 L_nm_39
    v_and_b32 v33, 15, v1
    v_lshlrev_b32 v33, 4, v33
    s_mov_b32 s9, 0
L_sx_40:
    s_add_u32 s9, s9, 1
    s_cmp_gt_u32 s9, 200000
    s_cbranch_scc1 L_BAIL
    ds_read_b128 v[92:95], v33 offset:2304
    ds_read_b128 v[96:99], v33 offset:2560
    ds_read_b128 v[100:103], v33 offset:2816
    ds_read_b128 v[104:107], v33 offset:3072
    s_waitcnt lgkmcnt(0)
    v_max_u32 v34, v92, v93
    v_max3_u32 v34, v34, v94, v95
    v_max3_u32 v34, v34, v96, v97
    v_max3_u32 v34, v34, v98, v99
    v_max3_u32 v34, v34, v100, v101
    v_max3_u32 v34, v34, v102, v103
    v_max3_u32 v34, v34, v104, v105
    v_max3_u32 v34, v34, v106, v107
    v_cmp_eq_u32 vcc, -1, v34
    s_cbranch_vccnz L_sx_40
    v_add_f32 v92, v92, v96
    v_add_f32 v100, v100, v104
    v_add_f32 v93, v93, v97
    v_add_f32 v101, v101, v105
    v_add_f32 v94, v94, v98
    v_add_f32 v102, v102, v106
    v_add_f32 v95, v95, v99
    v_add_f32 v103, v103, v107
    v_add_f32 v92, v92, v100
    v_add_f32 v93, v93, v101
    v_add_f32 v94, v94, v102
    v_add_f32 v95, v95, v103
    v_cvt_pk_bf16_f32 v92, v92, v93
    v_cvt_pk_bf16_f32 v94, v94, v95
    v_mov_b32 v93, s6
    v_mov_b32 v95, s6
    s_lshl_b32 s7, s97, 8
    s_add_u32 s7, s7, 131072
    v_and_b32 v33, 15, v1
    v_lshlrev_b32 v33, 4, v33
    v_lshrrev_b32 v32, 4, v1
    s_mov_b32 s8, 16384
    v_mul_lo_u32 v34, v32, s8
    v_add_u32 v33, v33, v34
    v_cmp_gt_u32 vcc, 4, v32
    v_mov_b32 v35, 0x40000000
    s_nop 0
    v_cndmask_b32 v33, v35, v33, vcc
    buffer_store_dwordx4 v[92:95], v33, s[44:47], s7 offen sc1
L_nm_39:
    s_cmp_lg_u32 s98, 1
    s_cbranch_scc1 L_b0b_41
    s_barrier
L_b0b_41:
    s_cmp_eq_u32 s3, 0
    s_cbranch_scc1 L_nclr_42
    v_mov_b32 v36, -1
    v_mov_b32 v37, -1
    v_mov_b32 v38, -1
    v_mov_b32 v39, -1
    v_lshlrev_b32 v30, 4, v1
    s_cmp_eq_u32 s3, 3
    s_cbranch_scc0 L_ca1_43
    s_lshl_b32 s7, s2, 10
    s_add_u32 s7, s7, 2097152
    v_cmp_gt_u32 vcc, 33, v1
    v_mov_b32 v35, 0x40000000
    s_nop 0
    v_cndmask_b32 v31, v35, v30, vcc
    buffer_store_dwordx4 v[36:39], v31, s[44:47], s7 offen sc1
    s_branch L_cad_44
L_ca1_43:
    s_cmp_eq_u32 s3, 1
    s_cbranch_scc0 L_cad_44
    s_cmp_eq_u32 s10, 0
    s_cbranch_scc0 L_cad_44
    s_mul_i32 s7, s11, 2560
    s_lshl_b32 s8, s12, 7
    s_add_u32 s7, s7, s8
    s_add_u32 s7, s7, 393216
    v_lshrrev_b32 v32, 3, v1
    s_mov_b32 s9, 20480
    v_mul_lo_u32 v31, v32, s9
    v_and_b32 v34, 7, v1
    v_lshl_add_u32 v31, v34, 4, v31
    v_cmp_gt_u32 vcc, 1, v32
    v_mov_b32 v35, 0x40000000
    s_nop 0
    v_cndmask_b32 v31, v35, v31, vcc
    buffer_store_dwordx4 v[36:39], v31, s[44:47], s7 offen sc1
L_cad_44:
    s_mul_i32 s7, s11, 2560
    s_sub_u32 s8, s3, 1
    s_lshl_b32 s8, s8, 10
    s_add_u32 s7, s7, s8
    s_add_u32 s7, s7, 589824
    s_cmp_eq_u32 s3, 3
    s_cselect_b32 s8, 32, 64
    s_cmp_eq_u32 s10, 1
    s_cselect_b32 s8, s8, 0
    v_cmp_gt_u32 vcc, s8, v1
    v_mov_b32 v35, 0x40000000
    s_nop 0
    v_cndmask_b32 v31, v35, v30, vcc
    buffer_store_dwordx4 v[36:39], v31, s[44:47], s7 offen sc1
    s_and_b32 s7, s2, 7
    s_cmp_eq_u32 s7, 0
    s_cselect_b32 s8, 1, 0
    s_cmp_eq_u32 s3, 2
    s_cselect_b32 s8, s8, 0
    s_mul_i32 s7, s5, 256
    s_add_u32 s7, s7, 1966080
    v_cmp_gt_u32 vcc, s8, v1
    v_mov_b32 v35, 0x40000000
    s_nop 0
    v_cndmask_b32 v31, v35, v2, vcc
    buffer_store_dword v2, v31, s[44:47], s7 offen sc1
    s_waitcnt vmcnt(0)
    v_mov_b32 v34, 1
    s_mov_b64 exec, 1
    ds_add_rtn_u32 v33, v2, v34 offset:11852
    s_mov_b64 exec, -1
    s_waitcnt lgkmcnt(0)
    v_readfirstlane_b32 s7, v33
    s_nop 0
    s_cmp_lg_u32 s7, 2
    s_cbranch_scc1 L_nclr_42
    v_cmp_eq_u32 vcc, 0, v1
    v_mov_b32 v35, 0x40000000
    s_nop 0
    v_cndmask_b32 v33, v35, v2, vcc
    buffer_atomic_add v34, v33, s[48:51], 0 offen
L_nclr_42:
    s_branch L_PJOIN
L_PQ:
    s_mov_b32 s52, s22
    s_and_b32 s53, s23, 0xffff
    s_mov_b32 s54, 0x500000
    s_mov_b32 s55, 0x20000
    v_lshlrev_b32 v30, 2, v1
    buffer_load_dword v20, v30, s[60:63], 0 offen offset:0
    buffer_load_dword v21, v30, s[60:63], 0 offen offset:256
    buffer_load_dword v22, v30, s[60:63], 0 offen offset:512
    buffer_load_dword v23, v30, s[60:63], 0 offen offset:768
    buffer_load_dword v24, v30, s[60:63], 0 offen offset:1024
    v_lshrrev_b32 v32, 3, v1
    v_and_b32 v33, 7, v1
    v_lshlrev_b32 v33, 4, v33
    s_mov_b32 s7, 8192
    v_mul_lo_u32 v28, v32, s7
    v_add_u32 v28, v28, v33
    s_mul_i32 s7, s3, 1310720
    s_lshl_b32 s8, s97, 7
    s_add_u32 s7, s7, s8
    s_mul_i32 s9, s3, 30720
    s_add_u32 m0, s9, 20480
    s_nop 0
    buffer_load_dwordx4 v28, s[52:55], s7 offen nt lds
    s_add_u32 s7, s7, 65536
    s_add_u32 m0, s9, 21504
    s_nop 0
    buffer_load_dwordx4 v28, s[52:55], s7 offen nt lds
    s_add_u32 s7, s7, 65536
    s_add_u32 m0, s9, 22528
    s_nop 0
    buffer_load_dwordx4 v28, s[52:55], s7 offen nt lds
    s_add_u32 s7, s7, 65536
    s_add_u32 m0, s9, 23552
    s_nop 0
    buffer_load_dwordx4 v28, s[52:55], s7 offen nt lds
    s_add_u32 s7, s7, 65536
    s_add_u32 m0, s9, 24576
    s_nop 0
    buffer_load_dwordx4 v28, s[52:55], s7 offen nt lds
    s_add_u32 s7, s7, 65536
    s_add_u32 m0, s9, 25600
    s_nop 0
    buffer_load_dwordx4 v28, s[52:55], s7 offen nt lds
    s_add_u32 s7, s7, 65536
    s_add_u32 m0, s9, 26624
    s_nop 0
    buffer_load_dwordx4 v28, s[52:55], s7 offen nt lds
    s_add_u32 s7, s7, 65536
    s_add_u32 m0, s9, 27648
    s_nop 0
    buffer_load_dwordx4 v28, s[52:55], s7 offen nt lds
    s_add_u32 s7, s7, 65536
    s_add_u32 m0, s9, 28672
    s_nop 0
    buffer_load_dwordx4 v28, s[52:55], s7 offen nt lds
    s_add_u32 s7, s7, 65536
    s_add_u32 m0, s9, 29696
    s_nop 0
    buffer_load_dwordx4 v28, s[52:55], s7 offen nt lds
    s_add_u32 s7, s7, 65536
    s_add_u32 m0, s9, 30720
    s_nop 0
    buffer_load_dwordx4 v28, s[52:55], s7 offen nt lds
    s_add_u32 s7, s7, 65536
    s_add_u32 m0, s9, 31744
    s_nop 0
    buffer_load_dwordx4 v28, s[52:55], s7 offen nt lds
    s_add_u32 s7, s7, 65536
    s_add_u32 m0, s9, 32768
    s_nop 0
    buffer_load_dwordx4 v28, s[52:55], s7 offen nt lds
    s_add_u32 s7, s7, 65536
    s_add_u32 m0, s9, 33792
    s_nop 0
    buffer_load_dwordx4 v28, s[52:55], s7 offen nt lds
    s_add_u32 s7, s7, 65536
    s_add_u32 m0, s9, 34816
    s_nop 0
    buffer_load_dwordx4 v28, s[52:55], s7 offen nt lds
    s_add_u32 s7, s7, 65536
    s_add_u32 m0, s9, 35840
    s_nop 0
    buffer_load_dwordx4 v28, s[52:55], s7 offen nt lds
    s_add_u32 s7, s7, 65536
    s_add_u32 m0, s9, 36864
    s_nop 0
    buffer_load_dwordx4 v28, s[52:55], s7 offen nt lds
    s_add_u32 s7, s7, 65536
    s_add_u32 m0, s9, 37888
    s_nop 0
    buffer_load_dwordx4 v28, s[52:55], s7 offen nt lds
    s_add_u32 s7, s7, 65536
    s_add_u32 m0, s9, 38912
    s_nop 0
    buffer_load_dwordx4 v28, s[52:55], s7 offen nt lds
    s_add_u32 s7, s7, 65536
    s_add_u32 m0, s9, 39936
    s_nop 0
    buffer_load_dwordx4 v28, s[52:55], s7 offen nt lds
    s_cmp_lg_u32 s98, 0
    s_cbranch_scc1 L_b0b_45
    s_barrier
L_b0b_45:
    s_waitcnt vmcnt(20)
    v_readfirstlane_b32 s6, v16
    s_nop 0
    s_mul_i32 s6, s6, 0x9E3779B1
    s_add_u32 s6, s6, 0x7F4A7C15
    v_lshlrev_b32 v8, 16, v26
    v_and_b32 v9, s13, v26
    v_lshlrev_b32 v10, 16, v27
    v_and_b32 v11, s13, v27
    v_lshlrev_b32 v140, 16, v20
    v_and_b32 v141, s13, v20
    v_lshlrev_b32 v142, 16, v21
    v_and_b32 v143, s13, v21
    v_lshlrev_b32 v144, 16, v22
    v_and_b32 v145, s13, v22
    v_lshlrev_b32 v146, 16, v23
    v_and_b32 v147, s13, v23
    v_lshlrev_b32 v148, 16, v24
    v_and_b32 v149, s13, v24
    v_add_f32 v28, v140, v141
    v_add_f32 v28, v28, v142
    v_add_f32 v28, v28, v143
    v_add_f32 v28, v28, v144
    v_add_f32 v28, v28, v145
    v_add_f32 v28, v28, v146
    v_add_f32 v28, v28, v147
    v_add_f32 v28, v28, v148
    v_add_f32 v28, v28, v149
    s_nop 1
    v_add_f32_dpp v28, v28, v28 quad_perm:[1,0,3,2] row_mask:0xf bank_mask:0xf
    s_nop 1
    v_add_f32_dpp v28, v28, v28 quad_perm:[2,3,0,1] row_mask:0xf bank_mask:0xf
    s_nop 1
    v_add_f32_dpp v28, v28, v28 row_ror:4 row_mask:0xf bank_mask:0xf
    s_nop 1
    v_add_f32_dpp v28, v28, v28 row_ror:8 row_mask:0xf bank_mask:0xf
    v_mov_b32 v32, v28
    s_nop 1
    v_permlane16_swap_b32 v28, v32
    v_add_f32 v28, v28, v32
    v_mov_b32 v32, v28
    s_nop 1
    v_permlane32_swap_b32 v28, v32
    v_add_f32 v28, v28, v32
    v_mul_f32 v28, 0x3acccccd, v28
    v_sub_f32 v32, v140, v28
    v_mul_f32 v29, v32, v32
    v_sub_f32 v32, v141, v28
    v_fma_f32 v29, v32, v32, v29
    v_sub_f32 v32, v142, v28
    v_fma_f32 v29, v32, v32, v29
    v_sub_f32 v32, v143, v28
    v_fma_f32 v29, v32, v32, v29
    v_sub_f32 v32, v144, v28
    v_fma_f32 v29, v32, v32, v29
    v_sub_f32 v32, v145, v28
    v_fma_f32 v29, v32, v32, v29
    v_sub_f32 v32, v146, v28
    v_fma_f32 v29, v32, v32, v29
    v_sub_f32 v32, v147, v28
    v_fma_f32 v29, v32, v32, v29
    v_sub_f32 v32, v148, v28
    v_fma_f32 v29, v32, v32, v29
    v_sub_f32 v32, v149, v28
    v_fma_f32 v29, v32, v32, v29
    s_nop 1
    v_add_f32_dpp v29, v29, v29 quad_perm:[1,0,3,2] row_mask:0xf bank_mask:0xf
    s_nop 1
    v_add_f32_dpp v29, v29, v29 quad_perm:[2,3,0,1] row_mask:0xf bank_mask:0xf
    s_nop 1
    v_add_f32_dpp v29, v29, v29 row_ror:4 row_mask:0xf bank_mask:0xf
    s_nop 1
    v_add_f32_dpp v29, v29, v29 row_ror:8 row_mask:0xf bank_mask:0xf
    v_mov_b32 v32, v29
    s_nop 1
    v_permlane16_swap_b32 v29, v32
    v_add_f32 v29, v29, v32
    v_mov_b32 v32, v29
    s_nop 1
    v_permlane32_swap_b32 v29, v32
    v_add_f32 v29, v29, v32
    v_mul_f32 v29, 0x3acccccd, v29
    v_cvt_pk_bf16_f32 v29, v29, v29
    v_and_b32 v29, 0xffff0000, v29
    v_add_f32 v29, 0x3727c5ac, v29
    v_cvt_pk_bf16_f32 v29, v29, v29
    v_and_b32 v29, 0xffff0000, v29
    v_sqrt_f32 v29, v29
    s_nop 0
    v_cvt_pk_bf16_f32 v29, v29, v29
    v_and_b32 v29, 0xffff0000, v29
    v_cvt_pk_bf16_f32 v28, v28, v28
    v_and_b32 v28, 0xffff0000, v28
    v_rcp_f32 v32, v29
    v_sub_f32 v20, v8, v28
    v_cvt_pk_bf16_f32 v20, v20, v20
    v_and_b32 v20, 0xffff0000, v20
    v_mul_f32 v33, v20, v32
    v_fma_f32 v34, -v33, v29, v20
    v_fma_f32 v20, v34, v32, v33
    v_cvt_pk_bf16_f32 v20, v20, v20
    v_and_b32 v20, 0xffff0000, v20
    v_sub_f32 v21, v9, v28
    v_cvt_pk_bf16_f32 v21, v21, v21
    v_and_b32 v21, 0xffff0000, v21
    v_mul_f32 v33, v21, v32
    v_fma_f32 v34, -v33, v29, v21
    v_fma_f32 v21, v34, v32, v33
    v_cvt_pk_bf16_f32 v21, v21, v21
    v_and_b32 v21, 0xffff0000, v21
    v_sub_f32 v22, v10, v28
    v_cvt_pk_bf16_f32 v22, v22, v22
    v_and_b32 v22, 0xffff0000, v22
    v_mul_f32 v33, v22, v32
    v_fma_f32 v34, -v33, v29, v22
    v_fma_f32 v22, v34, v32, v33
    v_cvt_pk_bf16_f32 v22, v22, v22
    v_and_b32 v22, 0xffff0000, v22
    v_sub_f32 v23, v11, v28
    v_cvt_pk_bf16_f32 v23, v23, v23
    v_and_b32 v23, 0xffff0000, v23
    v_mul_f32 v33, v23, v32
    v_fma_f32 v34, -v33, v29, v23
    v_fma_f32 v23, v34, v32, v33
    v_cvt_pk_bf16_f32 v23, v23, v23
    v_and_b32 v23, 0xffff0000, v23
    s_waitcnt vmcnt(0)
    s_mul_i32 s7, s3, 30720
    v_add_u32 v32, s7, v15
    ds_read_b64_tr_b16 v[40:41], v32 offset:20480
    ds_read_b64_tr_b16 v[42:43], v32 offset:20992
    ds_read_b64_tr_b16 v[60:61], v32 offset:20512
    ds_read_b64_tr_b16 v[62:63], v32 offset:21024
    ds_read_b64_tr_b16 v[80:81], v32 offset:20544
    ds_read_b64_tr_b16 v[82:83], v32 offset:21056
    ds_read_b64_tr_b16 v[100:101], v32 offset:20576
    ds_read_b64_tr_b16 v[102:103], v32 offset:21088
    ds_read_b64_tr_b16 v[44:45], v32 offset:24576
    ds_read_b64_tr_b16 v[46:47], v32 offset:25088
    ds_read_b64_tr_b16 v[64:65], v32 offset:24608
    ds_read_b64_tr_b16 v[66:67], v32 offset:25120
    ds_read_b64_tr_b16 v[84:85], v32 offset:24640
    ds_read_b64_tr_b16 v[86:87], v32 offset:25152
    ds_read_b64_tr_b16 v[104:105], v32 offset:24672
    ds_read_b64_tr_b16 v[106:107], v32 offset:25184
    s_waitcnt lgkmcnt(0)
    ds_read_b64_tr_b16 v[48:49], v32 offset:28672
    ds_read_b64_tr_b16 v[50:51], v32 offset:29184
    ds_read_b64_tr_b16 v[68:69], v32 offset:28704
    ds_read_b64_tr_b16 v[70:71], v32 offset:29216
    ds_read_b64_tr_b16 v[88:89], v32 offset:28736
    ds_read_b64_tr_b16 v[90:91], v32 offset:29248
    ds_read_b64_tr_b16 v[108:109], v32 offset:28768
    ds_read_b64_tr_b16 v[110:111], v32 offset:29280
    ds_read_b64_tr_b16 v[52:53], v32 offset:32768
    ds_read_b64_tr_b16 v[54:55], v32 offset:33280
    ds_read_b64_tr_b16 v[72:73], v32 offset:32800
    ds_read_b64_tr_b16 v[74:75], v32 offset:33312
    ds_read_b64_tr_b16 v[92:93], v32 offset:32832
    ds_read_b64_tr_b16 v[94:95], v32 offset:33344
    ds_read_b64_tr_b16 v[112:113], v32 offset:32864
    ds_read_b64_tr_b16 v[114:115], v32 offset:33376
    s_waitcnt lgkmcnt(0)
    ds_read_b64_tr_b16 v[56:57], v32 offset:36864
    ds_read_b64_tr_b16 v[58:59], v32 offset:37376
    ds_read_b64_tr_b16 v[76:77], v32 offset:36896
    ds_read_b64_tr_b16 v[78:79], v32 offset:37408
    ds_read_b64_tr_b16 v[96:97], v32 offset:36928
    ds_read_b64_tr_b16 v[98:99], v32 offset:37440
    ds_read_b64_tr_b16 v[116:117], v32 offset:36960
    ds_read_b64_tr_b16 v[118:119], v32 offset:37472
    s_waitcnt lgkmcnt(0)
    s_and_b32 s99, s97, 3
    s_mul_i32 s99, s99, 16384
    s_add_u32 s7, s99, 131072
    buffer_load_dwordx4 v[140:143], v14, s[44:47], s7 offen sc1
    s_add_u32 s7, s99, 133632
    buffer_load_dwordx4 v[144:147], v14, s[44:47], s7 offen sc1
    s_sleep 4
    s_mov_b32 s9, 0
L_pm_46:
    s_add_u32 s9, s9, 1
    s_cmp_gt_u32 s9, 200000
    s_cbranch_scc1 L_BAIL
    s_add_u32 s7, s99, 131072
    buffer_load_dwordx4 v[148:151], v14, s[44:47], s7 offen sc1
    s_add_u32 s7, s99, 133632
    buffer_load_dwordx4 v[152:155], v14, s[44:47], s7 offen sc1
    s_waitcnt vmcnt(2)
    v_xor_b32 v34, s6, v141
    v_xor_b32 v35, s6, v143
    v_or_b32 v34, v34, v35
    v_xor_b32 v35, s6, v145
    v_or_b32 v34, v34, v35
    v_xor_b32 v35, s6, v147
    v_or_b32 v34, v34, v35
    v_cmp_ne_u32 vcc, 0, v34
    s_nop 0
    s_and_b64 vcc, vcc, s[14:15]
    s_cbranch_vccz L_pm_46_ok_48
    s_add_u32 s7, s99, 131072
    buffer_load_dwordx4 v[140:143], v14, s[44:47], s7 offen sc1
    s_add_u32 s7, s99, 133632
    buffer_load_dwordx4 v[144:147], v14, s[44:47], s7 offen sc1
    s_waitcnt vmcnt(2)
    v_xor_b32 v34, s6, v149
    v_xor_b32 v35, s6, v151
    v_or_b32 v34, v34, v35
    v_xor_b32 v35, s6, v153
    v_or_b32 v34, v34, v35
    v_xor_b32 v35, s6, v155
    v_or_b32 v34, v34, v35
    v_cmp_ne_u32 vcc, 0, v34
    s_nop 0
    s_and_b64 vcc, vcc, s[14:15]
    s_cbranch_vccz L_pm_46_ok_49
    s_branch L_pm_46
L_pm_46_ok_48:
    v_lshlrev_b32 v160, 16, v140
    v_and_b32 v161, s13, v140
    v_lshlrev_b32 v162, 16, v142
    v_and_b32 v163, s13, v142
    v_lshlrev_b32 v156, 16, v144
    v_and_b32 v157, s13, v144
    v_lshlrev_b32 v158, 16, v146
    v_and_b32 v159, s13, v146
    s_branch L_pm_46_done_47
L_pm_46_ok_49:
    v_lshlrev_b32 v160, 16, v148
    v_and_b32 v161, s13, v148
    v_lshlrev_b32 v162, 16, v150
    v_and_b32 v163, s13, v150
    v_lshlrev_b32 v156, 16, v152
    v_and_b32 v157, s13, v152
    v_lshlrev_b32 v158, 16, v154
    v_and_b32 v159, s13, v154
L_pm_46_done_47:
    v_add_f32 v156, 1.0, v156
    v_add_f32 v157, 1.0, v157
    v_add_f32 v158, 1.0, v158
    v_add_f32 v159, 1.0, v159
    v_cvt_pk_bf16_f32 v156, v156, v156
    v_and_b32 v156, 0xffff0000, v156
    v_cvt_pk_bf16_f32 v157, v157, v157
    v_and_b32 v157, 0xffff0000, v157
    v_cvt_pk_bf16_f32 v158, v158, v158
    v_and_b32 v158, 0xffff0000, v158
    v_cvt_pk_bf16_f32 v159, v159, v159
    v_and_b32 v159, 0xffff0000, v159
    v_mul_f32 v156, v20, v156
    v_mul_f32 v157, v21, v157
    v_mul_f32 v158, v22, v158
    v_mul_f32 v159, v23, v159
    v_cvt_pk_bf16_f32 v156, v156, v156
    v_and_b32 v156, 0xffff0000, v156
    v_cvt_pk_bf16_f32 v157, v157, v157
    v_and_b32 v157, 0xffff0000, v157
    v_cvt_pk_bf16_f32 v158, v158, v158
    v_and_b32 v158, 0xffff0000, v158
    v_cvt_pk_bf16_f32 v159, v159, v159
    v_and_b32 v159, 0xffff0000, v159
    v_add_f32 v156, v156, v160
    v_add_f32 v157, v157, v161
    v_add_f32 v158, v158, v162
    v_add_f32 v159, v159, v163
    v_cvt_pk_bf16_f32 v164, v156, v157
    v_cvt_pk_bf16_f32 v165, v158, v159
    ds_write_b64 v12, v[164:165] offset:256
    ds_read_b128 v[120:123], v13 offset:256
    ds_read_b128 v[124:127], v13 offset:320
    ds_read_b128 v[128:131], v13 offset:384
    ds_read_b128 v[132:135], v13 offset:448
    ds_read_b128 v[136:139], v13 offset:512
    s_waitcnt lgkmcnt(0)
    v_mfma_f32_16x16x32_bf16 v[16:19], v[40:43], v[120:123], 0
    v_mfma_f32_16x16x32_bf16 v[20:23], v[60:63], v[120:123], 0
    v_mfma_f32_16x16x32_bf16 v[24:27], v[80:83], v[120:123], 0
    v_mfma_f32_16x16x32_bf16 v[28:31], v[100:103], v[120:123], 0
    v_mfma_f32_16x16x32_bf16 v[16:19], v[44:47], v[124:127], v[16:19]
    v_mfma_f32_16x16x32_bf16 v[20:23], v[64:67], v[124:127], v[20:23]
    v_mfma_f32_16x16x32_bf16 v[24:27], v[84:87], v[124:127], v[24:27]
    v_mfma_f32_16x16x32_bf16 v[28:31], v[104:107], v[124:127], v[28:31]
    v_mfma_f32_16x16x32_bf16 v[16:19], v[48:51], v[128:131], v[16:19]
    v_mfma_f32_16x16x32_bf16 v[20:23], v[68:71], v[128:131], v[20:23]
    v_mfma_f32_16x16x32_bf16 v[24:27], v[88:91], v[128:131], v[24:27]
    v_mfma_f32_16x16x32_bf16 v[28:31], v[108:111], v[128:131], v[28:31]
    v_mfma_f32_16x16x32_bf16 v[16:19], v[52:55], v[132:135], v[16:19]
    v_mfma_f32_16x16x32_bf16 v[20:23], v[72:75], v[132:135], v[20:23]
    v_mfma_f32_16x16x32_bf16 v[24:27], v[92:95], v[132:135], v[24:27]
    v_mfma_f32_16x16x32_bf16 v[28:31], v[112:115], v[132:135], v[28:31]
    v_mfma_f32_16x16x32_bf16 v[16:19], v[56:59], v[136:139], v[16:19]
    v_mfma_f32_16x16x32_bf16 v[20:23], v[76:79], v[136:139], v[20:23]
    v_mfma_f32_16x16x32_bf16 v[24:27], v[96:99], v[136:139], v[24:27]
    v_mfma_f32_16x16x32_bf16 v[28:31], v[116:119], v[136:139], v[28:31]
    s_mul_i32 s7, s3, 256
    v_add_u32 v33, s7, v3
    s_mov_b32 exec_lo, 0x00010001
    s_mov_b32 exec_hi, 0x00010001
    s_nop 0
    ds_write_b128 v33, v[16:19] offset:2304
    s_nop 0
    ds_write_b128 v33, v[20:23] offset:2368
    s_nop 0
    ds_write_b128 v33, v[24:27] offset:2432
    s_nop 0
    ds_write_b128 v33, v[28:31] offset:2496
    s_mov_b64 exec, -1
    s_cmp_lg_u32 s3, 0
    s_cbranch_scc1 L_nq_50
    v_and_b32 v33, 15, v1
    v_lshlrev_b32 v33, 4, v33
    s_mov_b32 s9, 0
L_sx_51:
    s_add_u32 s9, s9, 1
    s_cmp_gt_u32 s9, 200000
    s_cbranch_scc1 L_BAIL
    ds_read_b128 v[92:95], v33 offset:2304
    ds_read_b128 v[96:99], v33 offset:2560
    ds_read_b128 v[100:103], v33 offset:2816
    ds_read_b128 v[104:107], v33 offset:3072
    s_waitcnt lgkmcnt(0)
    v_max_u32 v34, v92, v93
    v_max3_u32 v34, v34, v94, v95
    v_max3_u32 v34, v34, v96, v97
    v_max3_u32 v34, v34, v98, v99
    v_max3_u32 v34, v34, v100, v101
    v_max3_u32 v34, v34, v102, v103
    v_max3_u32 v34, v34, v104, v105
    v_max3_u32 v34, v34, v106, v107
    v_cmp_eq_u32 vcc, -1, v34
    s_cbranch_vccnz L_sx_51
    v_add_f32 v92, v92, v96
    v_add_f32 v100, v100, v104
    v_add_f32 v93, v93, v97
    v_add_f32 v101, v101, v105
    v_add_f32 v94, v94, v98
    v_add_f32 v102, v102, v106
    v_add_f32 v95, v95, v99
    v_add_f32 v103, v103, v107
    v_add_f32 v92, v92, v100
    v_add_f32 v93, v93, v101
    v_add_f32 v94, v94, v102
    v_add_f32 v95, v95, v103
    v_cvt_pk_bf16_f32 v92, v92, v93
    v_cvt_pk_bf16_f32 v94, v94, v95
    v_mov_b32 v93, s6
    v_mov_b32 v95, s6
    s_lshl_b32 s7, s97, 8
    s_add_u32 s7, s7, 36864
    v_and_b32 v33, 15, v1
    v_lshlrev_b32 v33, 4, v33
    v_lshrrev_b32 v32, 4, v1
    v_cmp_gt_u32 vcc, 1, v32
    v_mov_b32 v35, 0x40000000
    s_nop 0
    v_cndmask_b32 v33, v35, v33, vcc
    buffer_store_dwordx4 v[92:95], v33, s[44:47], s7 offen sc1
L_nq_50:
    s_cmp_lg_u32 s98, 1
    s_cbranch_scc1 L_b0b_52
    s_barrier
L_b0b_52:
    s_cmp_eq_u32 s3, 0
    s_cbranch_scc1 L_nclr_53
    v_mov_b32 v36, -1
    v_mov_b32 v37, -1
    v_mov_b32 v38, -1
    v_mov_b32 v39, -1
    v_lshlrev_b32 v30, 4, v1
    s_cmp_eq_u32 s3, 3
    s_cbranch_scc0 L_ca1_54
    s_lshl_b32 s7, s2, 10
    s_add_u32 s7, s7, 2097152
    v_cmp_gt_u32 vcc, 33, v1
    v_mov_b32 v35, 0x40000000
    s_nop 0
    v_cndmask_b32 v31, v35, v30, vcc
    buffer_store_dwordx4 v[36:39], v31, s[44:47], s7 offen sc1
    s_branch L_cad_55
L_ca1_54:
    s_cmp_eq_u32 s3, 1
    s_cbranch_scc0 L_cad_55
    s_cmp_eq_u32 s10, 0
    s_cbranch_scc0 L_cad_55
    s_mul_i32 s7, s11, 2560
    s_lshl_b32 s8, s12, 7
    s_add_u32 s7, s7, s8
    s_add_u32 s7, s7, 393216
    v_lshrrev_b32 v32, 3, v1
    s_mov_b32 s9, 20480
    v_mul_lo_u32 v31, v32, s9
    v_and_b32 v34, 7, v1
    v_lshl_add_u32 v31, v34, 4, v31
    v_cmp_gt_u32 vcc, 1, v32
    v_mov_b32 v35, 0x40000000
    s_nop 0
    v_cndmask_b32 v31, v35, v31, vcc
    buffer_store_dwordx4 v[36:39], v31, s[44:47], s7 offen sc1
L_cad_55:
    s_mul_i32 s7, s11, 2560
    s_sub_u32 s8, s3, 1
    s_lshl_b32 s8, s8, 10
    s_add_u32 s7, s7, s8
    s_add_u32 s7, s7, 589824
    s_cmp_eq_u32 s3, 3
    s_cselect_b32 s8, 32, 64
    s_cmp_eq_u32 s10, 1
    s_cselect_b32 s8, s8, 0
    v_cmp_gt_u32 vcc, s8, v1
    v_mov_b32 v35, 0x40000000
    s_nop 0
    v_cndmask_b32 v31, v35, v30, vcc
    buffer_store_dwordx4 v[36:39], v31, s[44:47], s7 offen sc1
    s_and_b32 s7, s2, 7
    s_cmp_eq_u32 s7, 0
    s_cselect_b32 s8, 1, 0
    s_cmp_eq_u32 s3, 2
    s_cselect_b32 s8, s8, 0
    s_mul_i32 s7, s5, 256
    s_add_u32 s7, s7, 1966080
    v_cmp_gt_u32 vcc, s8, v1
    v_mov_b32 v35, 0x40000000
    s_nop 0
    v_cndmask_b32 v31, v35, v2, vcc
    buffer_store_dword v2, v31, s[44:47], s7 offen sc1
    s_waitcnt vmcnt(0)
    v_mov_b32 v34, 1
    s_mov_b64 exec, 1
    ds_add_rtn_u32 v33, v2, v34 offset:11852
    s_mov_b64 exec, -1
    s_waitcnt lgkmcnt(0)
    v_readfirstlane_b32 s7, v33
    s_nop 0
    s_cmp_lg_u32 s7, 2
    s_cbranch_scc1 L_nclr_53
    v_cmp_eq_u32 vcc, 0, v1
    v_mov_b32 v35, 0x40000000
    s_nop 0
    v_cndmask_b32 v33, v35, v2, vcc
    buffer_atomic_add v34, v33, s[48:51], 0 offen
L_nclr_53:
L_PJOIN:
    s_cmp_lg_u32 s3, 0
    s_cbranch_scc1 L_nqp_56
    v_lshlrev_b32 v31, 3, v1
    s_lshl_b32 s8, s5, 9
    s_add_u32 s8, s8, 36864
    s_cmp_lg_u32 s4, 0
    s_cbranch_scc1 L_qd_57
    s_sleep 32
    s_sleep 32
    s_sleep 32
    s_sleep 32
L_qd_57:
    buffer_load_dwordx2 v[144:145], v31, s[44:47], s8 offen sc1
    s_sleep 10
    s_mov_b32 s9, 0
L_pq_58:
    s_add_u32 s9, s9, 1
    s_cmp_gt_u32 s9, 200000
    s_cbranch_scc1 L_BAIL
    buffer_load_dwordx2 v[146:147], v31, s[44:47], s8 offen sc1
    s_waitcnt vmcnt(1)
    v_cmp_ne_u32 vcc, s6, v145
    s_cbranch_vccz L_pq_58_ok_60
    s_sleep 6
    buffer_load_dwordx2 v[144:145], v31, s[44:47], s8 offen sc1
    s_waitcnt vmcnt(1)
    v_cmp_ne_u32 vcc, s6, v147
    s_cbranch_vccz L_pq_58_ok_61
    s_sleep 6
    s_branch L_pq_58
L_pq_58_ok_60:
    v_mov_b32 v92, v144
    s_branch L_pq_58_done_59
L_pq_58_ok_61:
    v_mov_b32 v92, v146
L_pq_58_done_59:
    v_lshlrev_b32 v33, 2, v1
    ds_write_b32 v33, v92 offset:0
    s_waitcnt lgkmcnt(0)
L_nqp_56:
    s_barrier
    s_cmp_eq_u32 s3, 3
    s_cbranch_scc1 L_stay_62
    s_cmp_eq_u32 s10, 3
    s_cbranch_scc1 L_CEND
    s_cmp_lg_u32 s10, 2
    s_cbranch_scc1 L_stay_62
    s_cmp_ge_u32 s3, 2
    s_cbranch_scc1 L_CEND
L_stay_62:
    s_mov_b32 s9, 0
L_pw_63:
    s_add_u32 s9, s9, 1
    s_cmp_gt_u32 s9, 200000
    s_cbranch_scc1 L_BAIL
    s_sleep 16
    ds_read_b32 v33, v2 offset:11840
    s_waitcnt lgkmcnt(0)
    v_readfirstlane_b32 s7, v33
    s_nop 0
    s_cmp_lt_u32 s7, 56
    s_cbranch_scc1 L_pw_63
    s_cmp_lg_u32 s10, 1
    s_cbranch_scc1 L_nmlp_64
    s_mov_b32 s9, 0
L_pm2_66:
    s_add_u32 s9, s9, 1
    s_cmp_gt_u32 s9, 200000
    s_cbranch_scc1 L_BAIL
    s_mov_b32 s7, 136192
    buffer_load_dwordx4 v[16:19], v14, s[44:47], s7 offen sc1
    s_mov_b32 s7, 138752
    buffer_load_dwordx4 v[20:23], v14, s[44:47], s7 offen sc1
    s_mov_b32 s7, 141312
    buffer_load_dwordx4 v[24:27], v14, s[44:47], s7 offen sc1
    s_waitcnt vmcnt(0)
    v_xor_b32 v34, s6, v17
    v_xor_b32 v35, s6, v19
    v_or_b32 v34, v34, v35
    v_xor_b32 v35, s6, v21
    v_or_b32 v34, v34, v35
    v_xor_b32 v35, s6, v23
    v_or_b32 v34, v34, v35
    v_xor_b32 v35, s6, v25
    v_or_b32 v34, v34, v35
    v_xor_b32 v35, s6, v27
    v_or_b32 v34, v34, v35
    v_cmp_ne_u32 vcc, 0, v34
    s_nop 0
    s_and_b64 vcc, vcc, s[14:15]
    s_cbranch_vccz L_pm2_66_ok_68
    s_sleep 32
    s_branch L_pm2_66
L_pm2_66_ok_68:
L_pm2_66_done_67:
    v_lshlrev_b32 v32, 16, v16
    v_and_b32 v33, s13, v16
    v_lshlrev_b32 v34, 16, v18
    v_and_b32 v35, s13, v18
    v_mov_b32 v16, v32
    v_mov_b32 v17, v33
    v_mov_b32 v18, v34
    v_mov_b32 v19, v35
    v_lshlrev_b32 v32, 16, v20
    v_and_b32 v33, s13, v20
    v_lshlrev_b32 v34, 16, v22
    v_and_b32 v35, s13, v22
    v_mov_b32 v20, v32
    v_mov_b32 v21, v33
    v_mov_b32 v22, v34
    v_mov_b32 v23, v35
    v_lshlrev_b32 v32, 16, v24
    v_and_b32 v33, s13, v24
    v_lshlrev_b32 v34, 16, v26
    v_and_b32 v35, s13, v26
    v_add_f32 v32, 1.0, v32
    v_cvt_pk_bf16_f32 v32, v32, v32
    v_and_b32 v32, 0xffff0000, v32
    v_mov_b32 v24, v32
    v_add_f32 v33, 1.0, v33
    v_cvt_pk_bf16_f32 v33, v33, v33
    v_and_b32 v33, 0xffff0000, v33
    v_mov_b32 v25, v33
    v_add_f32 v34, 1.0, v34
    v_cvt_pk_bf16_f32 v34, v34, v34
    v_and_b32 v34, 0xffff0000, v34
    v_mov_b32 v26, v34
    v_add_f32 v35, 1.0, v35
    v_cvt_pk_bf16_f32 v35, v35, v35
    v_and_b32 v35, 0xffff0000, v35
    v_mov_b32 v27, v35
L_nmlp_64:
    s_cmp_lg_u32 s10, 2
    s_cbranch_scc1 L_nfin_65
    s_cmp_ge_u32 s3, 2
    s_cbranch_scc1 L_nfin_65
    s_lshl_b32 s11, s11, 1
    s_add_u32 s11, s11, s3
    v_and_b32 v15, 15, v1
    v_lshrrev_b32 v33, 1, v15
    v_lshlrev_b32 v33, 3, v33
    s_lshl_b32 s7, s11, 6
    v_add_u32 v33, s7, v33
    s_mov_b32 s9, 0
L_pm3_69:
    s_add_u32 s9, s9, 1
    s_cmp_gt_u32 s9, 200000
    s_cbranch_scc1 L_BAIL
    s_mov_b32 s7, 136192
    buffer_load_dwordx2 v[16:17], v33, s[44:47], s7 offen sc1
    s_mov_b32 s7, 143872
    buffer_load_dwordx2 v[18:19], v33, s[44:47], s7 offen sc1
    s_waitcnt vmcnt(0)
    v_xor_b32 v34, s6, v17
    v_xor_b32 v35, s6, v19
    v_or_b32 v34, v34, v35
    v_cmp_ne_u32 vcc, 0, v34
    s_cbranch_vccz L_pm3ok_70
    s_sleep 32
    s_branch L_pm3_69
L_pm3ok_70:
    v_and_b32 v34, 1, v15
    v_cmp_eq_u32 vcc, 1, v34
    v_lshlrev_b32 v34, 16, v16
    v_and_b32 v16, s13, v16
    v_cndmask_b32 v16, v34, v16, vcc
    v_lshlrev_b32 v34, 16, v18
    v_and_b32 v18, s13, v18
    v_cndmask_b32 v18, v34, v18, vcc
    s_mov_b32 s60, s16
    s_and_b32 s61, s17, 0xffff
    s_mov_b32 s62, 0x500
    s_mov_b32 s63, 0x20000
    s_lshl_b32 s7, s11, 5
    v_lshlrev_b32 v34, 1, v15
    buffer_load_ushort v20, v34, s[60:63], s7 offen
    s_waitcnt vmcnt(0)
    v_lshlrev_b32 v20, 16, v20
L_nfin_65:
    s_cmp_lg_u32 s3, 3
    s_cbranch_scc1 L_mgs_71
    s_mov_b32 s9, 0
L_pc_74:
    s_add_u32 s9, s9, 1
    s_cmp_gt_u32 s9, 200000
    s_cbranch_scc1 L_BAIL
    buffer_load_dword v33, v2, s[48:51], 0 offen sc1
    s_waitcnt vmcnt(0)
    v_cmp_gt_u32 vcc, 256, v33
    s_cbranch_vccz L_pcok_75
    s_sleep 64
    s_branch L_pc_74
L_pcok_75:
    s_mul_i32 s7, s5, 256
    s_add_u32 s7, s7, 1966080
    s_add_u32 s60, s42, s7
    s_addc_u32 s61, s43, 0
    s_mov_b32 s62, 0
    s_mov_b32 s63, 768
    s_mov_b32 s97, 8
    s_mov_b32 s54, 0
    s_mov_b32 s55, 0
    v_mov_b32 v39, 0x3d2aaaab
    v_mov_b32 v38, 0x3e000000
    s_mov_b32 s9, 0
L_mgl_72:
    s_add_u32 s9, s9, 1
    s_cmp_gt_u32 s9, 3200000
    s_cbranch_scc1 L_BAIL
    ds_read_b32 v33, v2 offset:11840
    s_waitcnt lgkmcnt(0)
    v_readfirstlane_b32 s98, v33
    s_nop 0
    s_add_u32 s7, s98, s97
    s_add_u32 s8, s62, 160
    s_cmp_gt_u32 s7, s8
    s_cbranch_scc1 L_mgg_76
    s_sleep 3
    s_branch L_mgl_72
L_mgg_76:
    v_cvt_f32_u32 v33, s63
    v_mul_f32 v33, v33, v39
    v_cvt_u32_f32 v33, v33
    s_nop 0
    v_readfirstlane_b32 s7, v33
    s_nop 0
    s_max_u32 s7, s7, 4
    s_min_u32 s7, s7, 64
    s_mov_b32 s8, s7
    s_atomic_add s8, s[60:61], 0 glc
    s_waitcnt lgkmcnt(0)
    s_sub_u32 s96, s98, s54
    s_sub_u32 s99, s8, s55
    s_mov_b32 s54, s98
    s_mov_b32 s55, s8
    s_cmp_eq_u32 s62, 0
    s_cbranch_scc1 L_mgsh_77
    s_max_u32 s99, s99, 1
    v_cvt_f32_u32 v33, s96
    v_cvt_f32_u32 v34, s99
    v_rcp_f32 v34, v34
    s_nop 0
    v_mul_f32 v33, v33, v34
    v_min_f32 v33, 0x3e4ccccd, v33
    v_mul_f32 v39, 0x3eb33333, v33
L_mgsh_77:
    v_add_u32 v33, s8, v1
    v_mul_u32_u24 v34, 683, v33
    v_lshrrev_b32 v34, 16, v34
    v_mul_u32_u24 v35, 96, v34
    v_sub_u32 v35, v33, v35
    v_add_u32 v35, 160, v35
    v_add_u32 v34, s5, v34
    v_and_b32 v34, 7, v34
    v_lshlrev_b32 v34, 20, v34
    v_lshl_add_u32 v34, v35, 12, v34
    v_cmp_gt_u32 vcc, 768, v33
    v_mov_b32 v35, -2
    s_nop 0
    v_cndmask_b32 v34, v35, v34, vcc
    v_add_u32 v35, s62, v1
    v_lshlrev_b32 v35, 2, v35
    v_cmp_gt_u32 vcc, s7, v1
    s_nop 0
    s_and_saveexec_b64 s[100:101], vcc
    ds_write_b32 v35, v34 offset:12288
    s_mov_b64 exec, -1
    s_add_u32 s62, s62, s7
    s_add_u32 s8, s8, s7
    s_cmp_ge_u32 s8, 768
    s_cbranch_scc1 L_mge_73
    s_cmp_lg_u32 s10, 1
    s_cbranch_scc1 L_mgns_78
    s_cmp_ge_u32 s8, 576
    s_cbranch_scc1 L_mge_73
L_mgns_78:
    s_sub_u32 s63, 768, s8
    s_mov_b32 s9, 0
    s_branch L_mgl_72
L_mge_73:
    v_add_u32 v35, s62, v1
    v_lshlrev_b32 v35, 2, v35
    v_mov_b32 v34, -2
    ds_write_b32 v35, v34 offset:12288
    v_mov_b32 v34, 1
    ds_write_b32 v2, v34 offset:11844
    s_cmp_ge_u32 s10, 2
    s_cbranch_scc1 L_CEND
L_mgs_71:
    s_mov_b32 s9, 0
L_trig_79:
    s_add_u32 s9, s9, 1
    s_cmp_gt_u32 s9, 3200000
    s_cbranch_scc1 L_BAIL
    s_sleep 2
    ds_read_b32 v33, v2 offset:11844
    s_waitcnt lgkmcnt(0)
    v_readfirstlane_b32 s7, v33
    s_nop 0
    s_cmp_eq_u32 s7, 0
    s_cbranch_scc1 L_trig_79
    s_setprio 0
    s_cmp_lg_u32 s10, 0
    s_cbranch_scc1 L_br_80
    s_mov_b32 s52, s24
    s_and_b32 s53, s25, 0xffff
    s_mov_b32 s54, 0x500000
    s_mov_b32 s55, 0x20000
    v_lshrrev_b32 v33, 2, v1
    s_mov_b32 s7, 1280
    v_mul_lo_u32 v33, v33, s7
    v_and_b32 v34, 3, v1
    v_lshl_add_u32 v33, v34, 4, v33
    s_lshl_b32 s7, s11, 2
    s_add_u32 s7, s7, s3
    s_mul_i32 s7, s7, 163840
    s_lshl_b32 s8, s12, 6
    s_add_u32 s7, s7, s8
    s_mul_i32 s9, s3, 30720
    s_add_u32 m0, s9, 20480
    s_nop 0
    buffer_load_dwordx4 v33, s[52:55], s7 offen nt lds
    s_add_u32 s7, s7, 20480
    s_add_u32 m0, s9, 21504
    s_nop 0
    buffer_load_dwordx4 v33, s[52:55], s7 offen nt lds
    s_add_u32 s7, s7, 20480
    s_add_u32 m0, s9, 22528
    s_nop 0
    buffer_load_dwordx4 v33, s[52:55], s7 offen nt lds
    s_add_u32 s7, s7, 20480
    s_add_u32 m0, s9, 23552
    s_nop 0
    buffer_load_dwordx4 v33, s[52:55], s7 offen nt lds
    s_add_u32 s7, s7, 20480
    s_add_u32 m0, s9, 24576
    s_nop 0
    buffer_load_dwordx4 v33, s[52:55], s7 offen nt lds
    s_add_u32 s7, s7, 20480
    s_add_u32 m0, s9, 25600
    s_nop 0
    buffer_load_dwordx4 v33, s[52:55], s7 offen nt lds
    s_add_u32 s7, s7, 20480
    s_add_u32 m0, s9, 26624
    s_nop 0
    buffer_load_dwordx4 v33, s[52:55], s7 offen nt lds
    s_add_u32 s7, s7, 20480
    s_add_u32 m0, s9, 27648
    s_nop 0
    buffer_load_dwordx4 v33, s[52:55], s7 offen nt lds
    s_branch L_brd_81
L_br_80:
    s_cmp_lg_u32 s10, 1
    s_cbranch_scc1 L_brd_81
    s_mov_b32 s52, s28
    s_and_b32 s53, s29, 0xffff
    s_mov_b32 s54, 0x21c000
    s_mov_b32 s55, 0x20000
    s_mov_b32 s56, s30
    s_and_b32 s57, s31, 0xffff
    s_mov_b32 s58, 0x21c000
    s_mov_b32 s59, 0x20000
    v_lshrrev_b32 v33, 2, v1
    s_mov_b32 s7, 3456
    v_mul_lo_u32 v33, v33, s7
    v_and_b32 v34, 3, v1
    v_lshl_add_u32 v33, v34, 4, v33
    s_mul_i32 s7, s3, 552960
    s_lshl_b32 s8, s11, 6
    s_add_u32 s7, s7, s8
    s_mul_i32 s9, s3, 30720
    s_add_u32 m0, s9, 20480
    s_nop 0
    buffer_load_dwordx4 v33, s[52:55], s7 offen nt lds
    s_add_u32 m0, s9, 30720
    s_nop 0
    buffer_load_dwordx4 v33, s[56:59], s7 offen nt lds
    s_add_u32 s7, s7, 55296
    s_add_u32 m0, s9, 21504
    s_nop 0
    buffer_load_dwordx4 v33, s[52:55], s7 offen nt lds
    s_add_u32 m0, s9, 31744
    s_nop 0
    buffer_load_dwordx4 v33, s[56:59], s7 offen nt lds
    s_add_u32 s7, s7, 55296
    s_add_u32 m0, s9, 22528
    s_nop 0
    buffer_load_dwordx4 v33, s[52:55], s7 offen nt lds
    s_add_u32 m0, s9, 32768
    s_nop 0
    buffer_load_dwordx4 v33, s[56:59], s7 offen nt lds
    s_add_u32 s7, s7, 55296
    s_add_u32 m0, s9, 23552
    s_nop 0
    buffer_load_dwordx4 v33, s[52:55], s7 offen nt lds
    s_add_u32 m0, s9, 33792
    s_nop 0
    buffer_load_dwordx4 v33, s[56:59], s7 offen nt lds
    s_add_u32 s7, s7, 55296
    s_add_u32 m0, s9, 24576
    s_nop 0
    buffer_load_dwordx4 v33, s[52:55], s7 offen nt lds
    s_add_u32 m0, s9, 34816
    s_nop 0
    buffer_load_dwordx4 v33, s[56:59], s7 offen nt lds
    s_add_u32 s7, s7, 55296
    s_add_u32 m0, s9, 25600
    s_nop 0
    buffer_load_dwordx4 v33, s[52:55], s7 offen nt lds
    s_add_u32 m0, s9, 35840
    s_nop 0
    buffer_load_dwordx4 v33, s[56:59], s7 offen nt lds
    s_add_u32 s7, s7, 55296
    s_add_u32 m0, s9, 26624
    s_nop 0
    buffer_load_dwordx4 v33, s[52:55], s7 offen nt lds
    s_add_u32 m0, s9, 36864
    s_nop 0
    buffer_load_dwordx4 v33, s[56:59], s7 offen nt lds
    s_add_u32 s7, s7, 55296
    s_add_u32 m0, s9, 27648
    s_nop 0
    buffer_load_dwordx4 v33, s[52:55], s7 offen nt lds
    s_add_u32 m0, s9, 37888
    s_nop 0
    buffer_load_dwordx4 v33, s[56:59], s7 offen nt lds
    s_add_u32 s7, s7, 55296
    s_add_u32 m0, s9, 28672
    s_nop 0
    buffer_load_dwordx4 v33, s[52:55], s7 offen nt lds
    s_add_u32 m0, s9, 38912
    s_nop 0
    buffer_load_dwordx4 v33, s[56:59], s7 offen nt lds
    s_add_u32 s7, s7, 55296
    s_add_u32 m0, s9, 29696
    s_nop 0
    buffer_load_dwordx4 v33, s[52:55], s7 offen nt lds
    s_add_u32 m0, s9, 39936
    s_nop 0
    buffer_load_dwordx4 v33, s[56:59], s7 offen nt lds
    s_mov_b32 s52, s32
    s_and_b32 s53, s33, 0xffff
    s_mov_b32 s54, 0x21c000
    s_mov_b32 s55, 0x20000
    v_mul_u32_u24 v32, 3277, v1
    v_lshrrev_b32 v32, 16, v32
    v_mul_u32_u24 v34, 20, v32
    v_sub_u32 v34, v1, v34
    v_mul_u32_u24 v33, 1280, v32
    v_lshl_add_u32 v33, v34, 4, v33
    s_mul_i32 s7, s11, 40960
    s_mul_i32 s8, s3, 320
    s_add_u32 s7, s7, s8
    s_mov_b32 exec_hi, 0x0fffffff
    s_add_u32 m0, s9, 40960
    s_nop 0
    buffer_load_dwordx4 v33, s[52:55], s7 offen nt lds
    s_add_u32 s7, s7, 3840
    s_add_u32 m0, s9, 41920
    s_nop 0
    buffer_load_dwordx4 v33, s[52:55], s7 offen nt lds
    s_add_u32 s7, s7, 3840
    s_add_u32 m0, s9, 42880
    s_nop 0
    buffer_load_dwordx4 v33, s[52:55], s7 offen nt lds
    s_add_u32 s7, s7, 3840
    s_add_u32 m0, s9, 43840
    s_nop 0
    buffer_load_dwordx4 v33, s[52:55], s7 offen nt lds
    s_add_u32 s7, s7, 3840
    s_add_u32 m0, s9, 44800
    s_nop 0
    buffer_load_dwordx4 v33, s[52:55], s7 offen nt lds
    s_add_u32 s7, s7, 3840
    s_add_u32 m0, s9, 45760
    s_nop 0
    buffer_load_dwordx4 v33, s[52:55], s7 offen nt lds
    s_add_u32 s7, s7, 3840
    s_add_u32 m0, s9, 46720
    s_nop 0
    buffer_load_dwordx4 v33, s[52:55], s7 offen nt lds
    s_add_u32 s7, s7, 3840
    s_add_u32 m0, s9, 47680
    s_nop 0
    buffer_load_dwordx4 v33, s[52:55], s7 offen nt lds
    s_add_u32 s7, s7, 3840
    s_add_u32 m0, s9, 48640
    s_nop 0
    buffer_load_dwordx4 v33, s[52:55], s7 offen nt lds
    s_add_u32 s7, s7, 3840
    s_add_u32 m0, s9, 49600
    s_nop 0
    buffer_load_dwordx4 v33, s[52:55], s7 offen nt lds
    s_add_u32 s7, s7, 3840
    s_mov_b32 exec_hi, 0xff
    s_add_u32 m0, s9, 50560
    s_nop 0
    buffer_load_dwordx4 v33, s[52:55], s7 offen nt lds
    s_mov_b64 exec, -1
L_brd_81:
    s_setprio 3
    s_cmp_lg_u32 s10, 0
    s_cbranch_scc1 L_br_82
    s_waitcnt vmcnt(0)
    s_mul_i32 s9, s3, 30720
    v_add_u32 v32, s9, v5
    ds_read_b64_tr_b16 v[40:41], v32 offset:20480
    ds_read_b64_tr_b16 v[42:43], v32 offset:20736
    ds_read_b64_tr_b16 v[44:45], v32 offset:22528
    ds_read_b64_tr_b16 v[46:47], v32 offset:22784
    ds_read_b64_tr_b16 v[48:49], v32 offset:24576
    ds_read_b64_tr_b16 v[50:51], v32 offset:24832
    ds_read_b64_tr_b16 v[52:53], v32 offset:26624
    ds_read_b64_tr_b16 v[54:55], v32 offset:26880
    s_waitcnt lgkmcnt(0)
    ds_read_b64_tr_b16 v[56:57], v32 offset:20512
    ds_read_b64_tr_b16 v[58:59], v32 offset:20768
    ds_read_b64_tr_b16 v[60:61], v32 offset:22560
    ds_read_b64_tr_b16 v[62:63], v32 offset:22816
    ds_read_b64_tr_b16 v[64:65], v32 offset:24608
    ds_read_b64_tr_b16 v[66:67], v32 offset:24864
    ds_read_b64_tr_b16 v[68:69], v32 offset:26656
    ds_read_b64_tr_b16 v[70:71], v32 offset:26912
    s_waitcnt lgkmcnt(0)
    s_branch L_brd_83
L_br_82:
    s_cmp_lg_u32 s10, 1
    s_cbranch_scc1 L_brd_83
    s_waitcnt vmcnt(0)
    s_mul_i32 s9, s3, 30720
    v_add_u32 v32, s9, v5
    v_lshrrev_b32 v33, 5, v4
    v_mul_u32_u24 v33, 320, v33
    v_and_b32 v34, 31, v4
    v_add3_u32 v15, v33, v34, s9
    v_mov_b32 v14, v32
    ds_read_b64_tr_b16 v[40:41], v32 offset:20480
    ds_read_b64_tr_b16 v[42:43], v32 offset:20736
    ds_read_b64_tr_b16 v[44:45], v32 offset:22528
    ds_read_b64_tr_b16 v[46:47], v32 offset:22784
    ds_read_b64_tr_b16 v[48:49], v32 offset:24576
    ds_read_b64_tr_b16 v[50:51], v32 offset:24832
    ds_read_b64_tr_b16 v[52:53], v32 offset:26624
    ds_read_b64_tr_b16 v[54:55], v32 offset:26880
    ds_read_b64_tr_b16 v[56:57], v32 offset:28672
    ds_read_b64_tr_b16 v[58:59], v32 offset:28928
    s_waitcnt lgkmcnt(0)
    ds_read_b64_tr_b16 v[60:61], v32 offset:20512
    ds_read_b64_tr_b16 v[62:63], v32 offset:20768
    ds_read_b64_tr_b16 v[64:65], v32 offset:22560
    ds_read_b64_tr_b16 v[66:67], v32 offset:22816
    ds_read_b64_tr_b16 v[68:69], v32 offset:24608
    ds_read_b64_tr_b16 v[70:71], v32 offset:24864
    ds_read_b64_tr_b16 v[72:73], v32 offset:26656
    ds_read_b64_tr_b16 v[74:75], v32 offset:26912
    ds_read_b64_tr_b16 v[76:77], v32 offset:28704
    ds_read_b64_tr_b16 v[78:79], v32 offset:28960
    s_waitcnt lgkmcnt(0)
    ds_read_b64_tr_b16 v[80:81], v32 offset:30720
    ds_read_b64_tr_b16 v[82:83], v32 offset:30976
    ds_read_b64_tr_b16 v[84:85], v32 offset:32768
    ds_read_b64_tr_b16 v[86:87], v32 offset:33024
    ds_read_b64_tr_b16 v[88:89], v32 offset:34816
    ds_read_b64_tr_b16 v[90:91], v32 offset:35072
    ds_read_b64_tr_b16 v[92:93], v32 offset:36864
    ds_read_b64_tr_b16 v[94:95], v32 offset:37120
    ds_read_b64_tr_b16 v[96:97], v32 offset:38912
    ds_read_b64_tr_b16 v[98:99], v32 offset:39168
    s_waitcnt lgkmcnt(0)
    ds_read_b64_tr_b16 v[100:101], v32 offset:30752
    ds_read_b64_tr_b16 v[102:103], v32 offset:31008
    ds_read_b64_tr_b16 v[104:105], v32 offset:32800
    ds_read_b64_tr_b16 v[106:107], v32 offset:33056
    ds_read_b64_tr_b16 v[108:109], v32 offset:34848
    ds_read_b64_tr_b16 v[110:111], v32 offset:35104
    ds_read_b64_tr_b16 v[112:113], v32 offset:36896
    ds_read_b64_tr_b16 v[114:115], v32 offset:37152
    ds_read_b64_tr_b16 v[116:117], v32 offset:38944
    ds_read_b64_tr_b16 v[118:119], v32 offset:39200
    s_waitcnt lgkmcnt(0)
L_brd_83:
    s_mov_b32 s9, 0
L_e1g_84:
    s_add_u32 s9, s9, 1
    s_cmp_gt_u32 s9, 200000
    s_cbranch_scc1 L_BAIL
    ds_read_b32 v33, v2 offset:11848
    s_waitcnt lgkmcnt(0)
    v_readfirstlane_b32 s7, v33
    s_nop 0
    s_cmp_lt_u32 s7, 8
    s_cbranch_scc0 L_e1g_84_ok
    s_sleep 1
    s_branch L_e1g_84
L_e1g_84_ok:
    s_cmp_eq_u32 s10, 0
    s_cbranch_scc1 L_T2
    s_cmp_eq_u32 s10, 1
    s_cbranch_scc1 L_T3
    v_and_b32 v33, 7, v1
    v_lshlrev_b32 v33, 10, v33
    s_lshl_b32 s8, s5, 13
    s_add_u32 s8, s8, 2097664
    s_add_u32 s7, s2, s3
    s_and_b32 s7, s7, 0
    s_mul_i32 s7, s7, 262144
    s_add_u32 s8, s8, s7
    s_mov_b32 s9, 0
L_gate_85:
    s_add_u32 s9, s9, 1
    s_cmp_gt_u32 s9, 200000
    s_cbranch_scc1 L_BAIL
    s_sleep 4
    buffer_load_dwordx2 v[34:35], v33, s[44:47], s8 offen sc1
    s_waitcnt vmcnt(0)
    v_max_u32 v32, v34, v35
    v_cmp_eq_u32 vcc, -1, v32
    s_cbranch_vccnz L_gate_85
    s_branch L_T4
L_T2:
    s_lshl_b32 s4, s11, 2
    s_add_u32 s4, s4, s3
    v_and_b32 v31, 7, v1
    v_lshlrev_b32 v31, 10, v31
    v_and_b32 v33, 31, v1
    v_lshlrev_b32 v33, 4, v33
    v_lshrrev_b32 v32, 5, v1
    v_lshl_add_u32 v33, v32, 12, v33
    s_lshl_b32 s8, s4, 13
    s_add_u32 s8, s8, 2097152
    s_and_b32 s7, s12, 0
    s_mul_i32 s7, s7, 262144
    s_add_u32 s8, s8, s7
    s_add_u32 s63, s8, 512
    v_and_b32 v16, 31, v1
    v_lshlrev_b32 v16, 3, v16
    v_lshrrev_b32 v17, 5, v1
    v_lshl_add_u32 v16, v17, 2, v16
    s_lshl_b32 s7, s3, 9
    v_add_u32 v16, s7, v16
    s_mul_i32 s7, s11, 2560
    s_lshl_b32 s97, s12, 7
    s_add_u32 s97, s97, s7
    s_add_u32 s97, s97, 393216
    v_lshrrev_b32 v32, 3, v1
    s_mov_b32 s9, 20480
    v_mul_lo_u32 v17, v32, s9
    v_and_b32 v34, 7, v1
    v_lshl_add_u32 v17, v34, 4, v17
    v_cmp_gt_u32 vcc, 1, v32
    v_mov_b32 v35, 0x40000000
    s_nop 0
    v_cndmask_b32 v17, v35, v17, vcc
    s_lshl_b32 s7, s3, 7
    v_add_u32 v18, s7, v3
    v_and_b32 v19, 7, v1
    v_lshlrev_b32 v19, 4, v19
    s_mov_b32 s96, 0x3fb8aa3b
    s_mov_b32 s60, 0
    s_mov_b32 s61, 0xff
    s_mov_b32 s99, 0
    s_mov_b32 s9, 0
L_e1_86:
    s_add_u32 s9, s9, 1
    s_cmp_gt_u32 s9, 200000
    s_cbranch_scc1 L_BAIL
L_e1x_88:
    buffer_load_dwordx2 v[34:35], v31, s[44:47], s63 offen sc1
    s_bcnt1_i32_b32 s7, s61
    s_cmp_le_u32 s7, 8
    s_cselect_b32 s7, 0, s61
    s_lshr_b32 s62, s7, 4
    s_or_b32 s62, s62, s7
    s_or_b32 s62, s62, s60
    s_andn2_b32 s62, 15, s62
    s_bitcmp0_b32 s62, 0
    s_cbranch_scc1 L_e1s_89
    buffer_load_dwordx4 v[120:123], v33, s[44:47], s8 offen offset:0 sc1
L_e1s_89:
    s_bitcmp0_b32 s62, 1
    s_cbranch_scc1 L_e1s_90
    buffer_load_dwordx4 v[124:127], v33, s[44:47], s8 offen offset:1024 sc1
L_e1s_90:
    s_bitcmp0_b32 s62, 2
    s_cbranch_scc1 L_e1s_91
    buffer_load_dwordx4 v[128:131], v33, s[44:47], s8 offen offset:2048 sc1
L_e1s_91:
    s_bitcmp0_b32 s62, 3
    s_cbranch_scc1 L_e1s_92
    buffer_load_dwordx4 v[132:135], v33, s[44:47], s8 offen offset:3072 sc1
L_e1s_92:
    s_waitcnt vmcnt(0)
    v_max_u32 v32, v34, v35
    v_cmp_eq_u32 vcc, -1, v32
    s_nop 0
    s_and_b32 s61, vcc_lo, 0xff
    s_bitcmp0_b32 s62, 0
    s_cbranch_scc1 L_e1c_93
    v_max_u32 v32, v120, v121
    v_max3_u32 v32, v32, v122, v123
    v_cmp_eq_u32 vcc, -1, v32
    s_cbranch_vccnz L_e1c_93
    s_bitset1_b32 s60, 0
L_e1c_93:
    s_bitcmp0_b32 s62, 1
    s_cbranch_scc1 L_e1c_94
    v_max_u32 v32, v124, v125
    v_max3_u32 v32, v32, v126, v127
    v_cmp_eq_u32 vcc, -1, v32
    s_cbranch_vccnz L_e1c_94
    s_bitset1_b32 s60, 1
L_e1c_94:
    s_bitcmp0_b32 s62, 2
    s_cbranch_scc1 L_e1c_95
    v_max_u32 v32, v128, v129
    v_max3_u32 v32, v32, v130, v131
    v_cmp_eq_u32 vcc, -1, v32
    s_cbranch_vccnz L_e1c_95
    s_bitset1_b32 s60, 2
L_e1c_95:
    s_bitcmp0_b32 s62, 3
    s_cbranch_scc1 L_e1c_96
    v_max_u32 v32, v132, v133
    v_max3_u32 v32, v32, v134, v135
    v_cmp_eq_u32 vcc, -1, v32
    s_cbranch_vccnz L_e1c_96
    s_bitset1_b32 s60, 3
L_e1c_96:
    s_cmp_eq_u32 s60, 15
    s_cselect_b32 s7, s61, 1
    s_cmp_eq_u32 s7, 0
    s_cbranch_scc1 L_e1d_87
    s_bcnt1_i32_b32 s7, s61
    s_cmp_le_u32 s7, 8
    s_cbranch_scc1 L_e1_86
    s_sleep 2
    s_branch L_e1_86
L_e1d_87:
    v_max_f32_dpp v36, v34, v34 quad_perm:[1,0,3,2] row_mask:0xf bank_mask:0xf
    s_nop 1
    v_max_f32_dpp v36, v36, v36 quad_perm:[2,3,0,1] row_mask:0xf bank_mask:0xf
    s_nop 1
    v_max_f32_dpp v36, v36, v36 row_half_mirror row_mask:0xf bank_mask:0xf
    v_sub_f32 v38, v34, v36
    v_mul_f32 v38, s96, v38
    v_exp_f32 v38, v38
    s_nop 0
    v_mul_f32 v37, v38, v35
    s_nop 0
    v_mov_b32_dpp v28, v38 row_newbcast:0 row_mask:0x3 bank_mask:0xf
    v_mov_b32_dpp v29, v38 row_newbcast:1 row_mask:0x3 bank_mask:0xf
    v_mov_b32_dpp v30, v38 row_newbcast:2 row_mask:0x3 bank_mask:0xf
    v_mov_b32_dpp v34, v38 row_newbcast:3 row_mask:0x3 bank_mask:0xf
    v_add_f32_dpp v37, v37, v37 quad_perm:[1,0,3,2] row_mask:0xf bank_mask:0xf
    v_mov_b32_dpp v28, v38 row_newbcast:4 row_mask:0xc bank_mask:0xf
    v_mov_b32_dpp v29, v38 row_newbcast:5 row_mask:0xc bank_mask:0xf
    v_mov_b32_dpp v30, v38 row_newbcast:6 row_mask:0xc bank_mask:0xf
    v_mov_b32_dpp v34, v38 row_newbcast:7 row_mask:0xc bank_mask:0xf
    v_add_f32_dpp v37, v37, v37 quad_perm:[2,3,0,1] row_mask:0xf bank_mask:0xf
    v_mul_f32 v120, v120, v28
    v_mul_f32 v121, v121, v28
    v_mul_f32 v122, v122, v28
    v_mul_f32 v123, v123, v28
    v_add_f32_dpp v37, v37, v37 row_half_mirror row_mask:0xf bank_mask:0xf
    v_fma_f32 v120, v124, v29, v120
    v_fma_f32 v121, v125, v29, v121
    v_fma_f32 v122, v126, v29, v122
    v_fma_f32 v123, v127, v29, v123
    v_rcp_f32 v37, v37
    v_fma_f32 v120, v128, v30, v120
    v_fma_f32 v121, v129, v30, v121
    v_fma_f32 v122, v130, v30, v122
    v_fma_f32 v123, v131, v30, v123
    v_fma_f32 v120, v132, v34, v120
    v_fma_f32 v121, v133, v34, v121
    v_fma_f32 v122, v134, v34, v122
    v_fma_f32 v123, v135, v34, v123
    s_nop 0
    v_permlane32_swap_b32 v120, v122
    s_nop 0
    v_permlane32_swap_b32 v121, v123
    v_add_f32 v36, v120, v122
    v_add_f32 v38, v121, v123
    v_mul_f32 v36, v36, v37
    v_mul_f32 v38, v38, v37
    v_cvt_pk_bf16_f32 v36, v36, v38
    ds_write_b32 v16, v36 offset:256
    ds_read_b128 v[136:139], v13 offset:256
    ds_read_b128 v[140:143], v13 offset:320
    ds_read_b128 v[144:147], v13 offset:384
    ds_read_b128 v[148:151], v13 offset:448
    s_waitcnt lgkmcnt(0)
    v_mfma_f32_16x16x32_bf16 v[152:155], v[40:43], v[136:139], 0
    v_mfma_f32_16x16x32_bf16 v[156:159], v[56:59], v[136:139], 0
    v_mfma_f32_16x16x32_bf16 v[152:155], v[44:47], v[140:143], v[152:155]
    v_mfma_f32_16x16x32_bf16 v[156:159], v[60:63], v[140:143], v[156:159]
    v_mfma_f32_16x16x32_bf16 v[152:155], v[48:51], v[144:147], v[152:155]
    v_mfma_f32_16x16x32_bf16 v[156:159], v[64:67], v[144:147], v[156:159]
    v_mfma_f32_16x16x32_bf16 v[152:155], v[52:55], v[148:151], v[152:155]
    v_mfma_f32_16x16x32_bf16 v[156:159], v[68:71], v[148:151], v[156:159]
    s_mov_b32 exec_lo, 0x00010001
    s_mov_b32 exec_hi, 0x00010001
    s_nop 4
    ds_write_b128 v18, v[152:155] offset:3328
    s_nop 4
    ds_write_b128 v18, v[156:159] offset:3392
    s_mov_b64 exec, -1
    s_cmp_lg_u32 s3, 0
    s_cbranch_scc1 L_CEND
    s_mov_b32 s9, 0
L_sx3_97:
    s_add_u32 s9, s9, 1
    s_cmp_gt_u32 s9, 200000
    s_cbranch_scc1 L_BAIL
    ds_read_b128 v[120:123], v19 offset:3328
    ds_read_b128 v[124:127], v19 offset:3456
    ds_read_b128 v[128:131], v19 offset:3584
    ds_read_b128 v[132:135], v19 offset:3712
    s_waitcnt lgkmcnt(0)
    v_max_u32 v34, v120, v121
    v_max3_u32 v34, v34, v122, v123
    v_max3_u32 v34, v34, v124, v125
    v_max3_u32 v34, v34, v126, v127
    v_max3_u32 v34, v34, v128, v129
    v_max3_u32 v34, v34, v130, v131
    v_max3_u32 v34, v34, v132, v133
    v_max3_u32 v34, v34, v134, v135
    v_cmp_eq_u32 vcc, -1, v34
    s_cbranch_vccnz L_sx3_97
    v_add_f32 v120, v120, v124
    v_add_f32 v121, v121, v125
    v_add_f32 v122, v122, v126
    v_add_f32 v123, v123, v127
    v_add_f32 v128, v128, v132
    v_add_f32 v129, v129, v133
    v_add_f32 v130, v130, v134
    v_add_f32 v131, v131, v135
    v_add_f32 v120, v120, v128
    v_add_f32 v121, v121, v129
    v_add_f32 v122, v122, v130
    v_add_f32 v123, v123, v131
    buffer_store_dwordx4 v[120:123], v17, s[44:47], s97 offen sc1
    s_branch L_CEND
L_T3:
    v_lshlrev_b32 v33, 2, v7
    v_mov_b32 v35, 0x40000000
    v_cndmask_b32 v33, v35, v33, s[14:15]
    s_lshl_b32 s7, s3, 3
    v_mov_b32 v28, s7
    v_and_b32 v29, 3, v1
    v_lshlrev_b32 v29, 3, v29
    s_lshl_b32 s7, s3, 8
    v_add_u32 v30, s7, v3
    v_and_b32 v31, 31, v1
    v_lshlrev_b32 v31, 2, v31
    s_lshl_b32 s7, s3, 6
    v_lshrrev_b32 v36, 1, v31
    v_add_u32 v36, s7, v36
    v_add_u32 v37, s7, v3
    v_and_b32 v34, 15, v1
    v_cmp_eq_u32 vcc, 0, v34
    v_mov_b32 v35, 0x40000000
    s_nop 0
    v_cndmask_b32 v38, v35, v3, vcc
    s_mul_i32 s7, s11, 2560
    s_mul_i32 s8, s3, 640
    s_add_u32 s97, s7, s8
    s_add_u32 s97, s97, 589824
    s_and_b32 s61, s11, 0
    s_mul_i32 s61, s61, 20480
    s_add_u32 s61, s61, 393216
    s_add_u32 s7, s61, 0
    buffer_load_dwordx4 v[120:123], v33, s[44:47], s7 offen sc1
    s_add_u32 s7, s61, 2560
    buffer_load_dwordx4 v[124:127], v33, s[44:47], s7 offen sc1
    s_add_u32 s7, s61, 5120
    buffer_load_dwordx4 v[128:131], v33, s[44:47], s7 offen sc1
    s_add_u32 s7, s61, 7680
    buffer_load_dwordx4 v[132:135], v33, s[44:47], s7 offen sc1
    s_add_u32 s7, s61, 10240
    buffer_load_dwordx4 v[136:139], v33, s[44:47], s7 offen sc1
    s_add_u32 s7, s61, 12800
    buffer_load_dwordx4 v[140:143], v33, s[44:47], s7 offen sc1
    s_add_u32 s7, s61, 15360
    buffer_load_dwordx4 v[144:147], v33, s[44:47], s7 offen sc1
    s_add_u32 s7, s61, 17920
    buffer_load_dwordx4 v[148:151], v33, s[44:47], s7 offen sc1
    s_waitcnt vmcnt(0)
    v_max_u32 v32, v120, v121
    v_max3_u32 v32, v32, v122, v123
    v_max3_u32 v32, v32, v124, v125
    v_max3_u32 v32, v32, v126, v127
    v_max3_u32 v32, v32, v128, v129
    v_max3_u32 v32, v32, v130, v131
    v_max3_u32 v32, v32, v132, v133
    v_max3_u32 v32, v32, v134, v135
    v_max3_u32 v32, v32, v136, v137
    v_max3_u32 v32, v32, v138, v139
    v_max3_u32 v32, v32, v140, v141
    v_max3_u32 v32, v32, v142, v143
    v_max3_u32 v32, v32, v144, v145
    v_max3_u32 v32, v32, v146, v147
    v_max3_u32 v32, v32, v148, v149
    v_max3_u32 v32, v32, v150, v151
    v_cmp_eq_u32 vcc, -1, v32
    s_cbranch_vccz L_y1ok_98
    v_and_b32 v39, 7, v1
    v_lshlrev_b32 v39, 10, v39
    s_lshl_b32 s8, s5, 13
    s_add_u32 s8, s8, 2097664
    s_add_u32 s7, s2, s3
    s_and_b32 s7, s7, 0
    s_mul_i32 s7, s7, 262144
    s_add_u32 s8, s8, s7
    s_mov_b32 s9, 0
L_gate_100:
    s_add_u32 s9, s9, 1
    s_cmp_gt_u32 s9, 200000
    s_cbranch_scc1 L_BAIL
    s_sleep 4
    buffer_load_dwordx2 v[34:35], v39, s[44:47], s8 offen sc1
    s_waitcnt vmcnt(0)
    v_max_u32 v32, v34, v35
    v_cmp_eq_u32 vcc, -1, v32
    s_cbranch_vccnz L_gate_100
    s_mov_b32 s9, 0
L_py1_101:
    s_add_u32 s9, s9, 1
    s_cmp_gt_u32 s9, 200000
    s_cbranch_scc1 L_BAIL
    s_add_u32 s7, s61, 0
    buffer_load_dwordx4 v[120:123], v33, s[44:47], s7 offen sc1
    s_add_u32 s7, s61, 2560
    buffer_load_dwordx4 v[124:127], v33, s[44:47], s7 offen sc1
    s_add_u32 s7, s61, 5120
    buffer_load_dwordx4 v[128:131], v33, s[44:47], s7 offen sc1
    s_add_u32 s7, s61, 7680
    buffer_load_dwordx4 v[132:135], v33, s[44:47], s7 offen sc1
    s_add_u32 s7, s61, 10240
    buffer_load_dwordx4 v[136:139], v33, s[44:47], s7 offen sc1
    s_add_u32 s7, s61, 12800
    buffer_load_dwordx4 v[140:143], v33, s[44:47], s7 offen sc1
    s_add_u32 s7, s61, 15360
    buffer_load_dwordx4 v[144:147], v33, s[44:47], s7 offen sc1
    s_add_u32 s7, s61, 17920
    buffer_load_dwordx4 v[148:151], v33, s[44:47], s7 offen sc1
    s_waitcnt vmcnt(0)
    v_max_u32 v32, v120, v121
    v_max3_u32 v32, v32, v122, v123
    v_max3_u32 v32, v32, v124, v125
    v_max3_u32 v32, v32, v126, v127
    v_max3_u32 v32, v32, v128, v129
    v_max3_u32 v32, v32, v130, v131
    v_max3_u32 v32, v32, v132, v133
    v_max3_u32 v32, v32, v134, v135
    v_max3_u32 v32, v32, v136, v137
    v_max3_u32 v32, v32, v138, v139
    v_max3_u32 v32, v32, v140, v141
    v_max3_u32 v32, v32, v142, v143
    v_max3_u32 v32, v32, v144, v145
    v_max3_u32 v32, v32, v146, v147
    v_max3_u32 v32, v32, v148, v149
    v_max3_u32 v32, v32, v150, v151
    v_cmp_eq_u32 vcc, -1, v32
    s_cbranch_vccz L_py1_101_ok_103
    s_branch L_py1_101
L_py1_101_ok_103:
    v_add_f32 v120, v120, v124
    v_add_f32 v128, v128, v132
    v_add_f32 v136, v136, v140
    v_add_f32 v144, v144, v148
    v_add_f32 v120, v120, v128
    v_add_f32 v136, v136, v144
    v_add_f32 v164, v120, v136
    v_add_f32 v121, v121, v125
    v_add_f32 v129, v129, v133
    v_add_f32 v137, v137, v141
    v_add_f32 v145, v145, v149
    v_add_f32 v121, v121, v129
    v_add_f32 v137, v137, v145
    v_add_f32 v165, v121, v137
    v_add_f32 v122, v122, v126
    v_add_f32 v130, v130, v134
    v_add_f32 v138, v138, v142
    v_add_f32 v146, v146, v150
    v_add_f32 v122, v122, v130
    v_add_f32 v138, v138, v146
    v_add_f32 v166, v122, v138
    v_add_f32 v123, v123, v127
    v_add_f32 v131, v131, v135
    v_add_f32 v139, v139, v143
    v_add_f32 v147, v147, v151
    v_add_f32 v123, v123, v131
    v_add_f32 v139, v139, v147
    v_add_f32 v167, v123, v139
L_py1_101_done_102:
    s_branch L_y1dn_99
L_y1ok_98:
    v_add_f32 v120, v120, v124
    v_add_f32 v128, v128, v132
    v_add_f32 v136, v136, v140
    v_add_f32 v144, v144, v148
    v_add_f32 v120, v120, v128
    v_add_f32 v136, v136, v144
    v_add_f32 v164, v120, v136
    v_add_f32 v121, v121, v125
    v_add_f32 v129, v129, v133
    v_add_f32 v137, v137, v141
    v_add_f32 v145, v145, v149
    v_add_f32 v121, v121, v129
    v_add_f32 v137, v137, v145
    v_add_f32 v165, v121, v137
    v_add_f32 v122, v122, v126
    v_add_f32 v130, v130, v134
    v_add_f32 v138, v138, v142
    v_add_f32 v146, v146, v150
    v_add_f32 v122, v122, v130
    v_add_f32 v138, v138, v146
    v_add_f32 v166, v122, v138
    v_add_f32 v123, v123, v127
    v_add_f32 v131, v131, v135
    v_add_f32 v139, v139, v143
    v_add_f32 v147, v147, v151
    v_add_f32 v123, v123, v131
    v_add_f32 v139, v139, v147
    v_add_f32 v167, v123, v139
L_y1dn_99:
    v_mul_f32 v164, v16, v164
    v_mul_f32 v165, v17, v165
    v_mul_f32 v166, v18, v166
    v_mul_f32 v167, v19, v167
    v_add_f32 v160, v8, v164
    v_add_f32 v161, v9, v165
    v_add_f32 v162, v10, v166
    v_add_f32 v163, v11, v167
    v_cvt_pk_bf16_f32 v160, v160, v160
    v_and_b32 v160, 0xffff0000, v160
    v_cvt_pk_bf16_f32 v161, v161, v161
    v_and_b32 v161, 0xffff0000, v161
    v_cvt_pk_bf16_f32 v162, v162, v162
    v_and_b32 v162, 0xffff0000, v162
    v_cvt_pk_bf16_f32 v163, v163, v163
    v_and_b32 v163, 0xffff0000, v163
    v_readfirstlane_b32 s60, v160
    s_nop 1
    v_subrev_f32 v152, s60, v160
    s_nop 0
    v_subrev_f32 v153, s60, v161
    v_subrev_f32 v154, s60, v162
    v_subrev_f32 v155, s60, v163
    v_cndmask_b32 v152, 0, v152, s[14:15]
    v_cndmask_b32 v153, 0, v153, s[14:15]
    v_cndmask_b32 v154, 0, v154, s[14:15]
    v_cndmask_b32 v155, 0, v155, s[14:15]
    v_add_f32 v156, v152, v153
    v_add_f32 v158, v154, v155
    v_mul_f32 v157, v152, v152
    v_add_f32 v156, v156, v158
    v_fma_f32 v157, v153, v153, v157
    v_fma_f32 v157, v154, v154, v157
    v_fma_f32 v157, v155, v155, v157
    v_add_f32_dpp v156, v156, v156 quad_perm:[1,0,3,2] row_mask:0xf bank_mask:0xf
    s_nop 0
    v_add_f32_dpp v157, v157, v157 quad_perm:[1,0,3,2] row_mask:0xf bank_mask:0xf
    s_nop 0
    v_add_f32_dpp v156, v156, v156 quad_perm:[2,3,0,1] row_mask:0xf bank_mask:0xf
    s_nop 0
    v_add_f32_dpp v157, v157, v157 quad_perm:[2,3,0,1] row_mask:0xf bank_mask:0xf
    s_nop 0
    v_add_f32_dpp v156, v156, v156 row_ror:4 row_mask:0xf bank_mask:0xf
    s_nop 0
    v_add_f32_dpp v157, v157, v157 row_ror:4 row_mask:0xf bank_mask:0xf
    s_nop 0
    v_add_f32_dpp v156, v156, v156 row_ror:8 row_mask:0xf bank_mask:0xf
    s_nop 0
    v_add_f32_dpp v157, v157, v157 row_ror:8 row_mask:0xf bank_mask:0xf
    v_mov_b32 v158, v156
    v_mov_b32 v159, v157
    s_nop 0
    v_permlane16_swap_b32 v156, v158
    s_nop 0
    v_permlane16_swap_b32 v157, v159
    v_add_f32 v156, v156, v158
    v_add_f32 v157, v157, v159
    v_mov_b32 v158, v156
    v_mov_b32 v159, v157
    s_nop 0
    v_permlane32_swap_b32 v156, v158
    s_nop 0
    v_permlane32_swap_b32 v157, v159
    v_add_f32 v156, v156, v158
    v_add_f32 v157, v157, v159
    v_mul_f32 v158, 0x3bcccccd, v156
    v_fma_f32 v157, -v158, v156, v157
    v_add_f32 v156, s60, v158
    s_mov_b64 exec, 1
    ds_write_b64 v28, v[156:157] offset:4864
    s_mov_b64 exec, -1
    s_mov_b32 s9, 0
L_sx4_104:
    s_add_u32 s9, s9, 1
    s_cmp_gt_u32 s9, 200000
    s_cbranch_scc1 L_BAIL
    ds_read_b64 v[156:157], v29 offset:4864
    s_waitcnt lgkmcnt(0)
    v_max_u32 v34, v156, v157
    v_cmp_eq_u32 vcc, -1, v34
    s_cbranch_vccnz L_sx4_104
    v_add_f32_dpp v152, v156, v156 quad_perm:[1,0,3,2] row_mask:0xf bank_mask:0xf
    s_nop 1
    v_add_f32_dpp v152, v152, v152 quad_perm:[2,3,0,1] row_mask:0xf bank_mask:0xf
    v_mul_f32 v152, 0.25, v152
    v_sub_f32 v158, v156, v152
    v_mul_f32 v158, v158, v158
    v_fmac_f32 v157, 0x43200000, v158
    s_nop 1
    v_add_f32_dpp v153, v157, v157 quad_perm:[1,0,3,2] row_mask:0xf bank_mask:0xf
    s_nop 1
    v_add_f32_dpp v153, v153, v153 quad_perm:[2,3,0,1] row_mask:0xf bank_mask:0xf
    v_mul_f32 v153, 0x3acccccd, v153
    v_add_f32 v153, 0x3727c5ac, v153
    v_rsq_f32 v154, v153
    v_sub_f32 v156, v160, v152
    v_sub_f32 v157, v161, v152
    v_sub_f32 v158, v162, v152
    v_sub_f32 v159, v163, v152
    v_mul_f32 v156, v156, v154
    v_mul_f32 v157, v157, v154
    v_mul_f32 v158, v158, v154
    v_mul_f32 v159, v159, v154
    v_fma_f32 v156, v156, v24, v20
    v_fma_f32 v157, v157, v25, v21
    v_fma_f32 v158, v158, v26, v22
    v_fma_f32 v159, v159, v27, v23
    v_cvt_pk_bf16_f32 v164, v156, v157
    v_cvt_pk_bf16_f32 v165, v158, v159
    ds_write_b64 v12, v[164:165] offset:256
    ds_read_b128 v[120:123], v13 offset:256
    ds_read_b128 v[124:127], v13 offset:320
    ds_read_b128 v[128:131], v13 offset:384
    ds_read_b128 v[132:135], v13 offset:448
    ds_read_b128 v[136:139], v13 offset:512
    s_waitcnt lgkmcnt(0)
    v_mfma_f32_16x16x32_bf16 v[140:143], v[40:43], v[120:123], 0
    v_mfma_f32_16x16x32_bf16 v[144:147], v[60:63], v[120:123], 0
    v_mfma_f32_16x16x32_bf16 v[148:151], v[80:83], v[120:123], 0
    v_mfma_f32_16x16x32_bf16 v[152:155], v[100:103], v[120:123], 0
    v_mfma_f32_16x16x32_bf16 v[140:143], v[44:47], v[124:127], v[140:143]
    v_mfma_f32_16x16x32_bf16 v[144:147], v[64:67], v[124:127], v[144:147]
    v_mfma_f32_16x16x32_bf16 v[148:151], v[84:87], v[124:127], v[148:151]
    v_mfma_f32_16x16x32_bf16 v[152:155], v[104:107], v[124:127], v[152:155]
    v_mfma_f32_16x16x32_bf16 v[140:143], v[48:51], v[128:131], v[140:143]
    v_mfma_f32_16x16x32_bf16 v[144:147], v[68:71], v[128:131], v[144:147]
    v_mfma_f32_16x16x32_bf16 v[148:151], v[88:91], v[128:131], v[148:151]
    v_mfma_f32_16x16x32_bf16 v[152:155], v[108:111], v[128:131], v[152:155]
    v_mfma_f32_16x16x32_bf16 v[140:143], v[52:55], v[132:135], v[140:143]
    v_mfma_f32_16x16x32_bf16 v[144:147], v[72:75], v[132:135], v[144:147]
    v_mfma_f32_16x16x32_bf16 v[148:151], v[92:95], v[132:135], v[148:151]
    v_mfma_f32_16x16x32_bf16 v[152:155], v[112:115], v[132:135], v[152:155]
    v_mfma_f32_16x16x32_bf16 v[140:143], v[56:59], v[136:139], v[140:143]
    v_mfma_f32_16x16x32_bf16 v[144:147], v[76:79], v[136:139], v[144:147]
    v_mfma_f32_16x16x32_bf16 v[148:151], v[96:99], v[136:139], v[148:151]
    v_mfma_f32_16x16x32_bf16 v[152:155], v[116:119], v[136:139], v[152:155]
    s_mov_b32 exec_lo, 0x00010001
    s_mov_b32 exec_hi, 0x00010001
    s_nop 2
    ds_write_b128 v30, v[140:143] offset:3840
    s_nop 2
    ds_write_b128 v30, v[144:147] offset:3904
    s_nop 2
    ds_write_b128 v30, v[148:151] offset:3968
    s_nop 2
    ds_write_b128 v30, v[152:155] offset:4032
    s_mov_b64 exec, -1
    s_mov_b32 s9, 0
L_sx5_105:
    s_add_u32 s9, s9, 1
    s_cmp_gt_u32 s9, 200000
    s_cbranch_scc1 L_BAIL
    ds_read_b32 v120, v31 offset:3840
    ds_read_b32 v124, v31 offset:3968
    ds_read_b32 v121, v31 offset:4096
    ds_read_b32 v125, v31 offset:4224
    ds_read_b32 v122, v31 offset:4352
    ds_read_b32 v126, v31 offset:4480
    ds_read_b32 v123, v31 offset:4608
    ds_read_b32 v127, v31 offset:4736
    s_waitcnt lgkmcnt(0)
    v_max_u32 v34, v120, v121
    v_max3_u32 v34, v34, v122, v123
    v_max3_u32 v34, v34, v124, v125
    v_max3_u32 v34, v34, v126, v127
    v_cmp_eq_u32 vcc, -1, v34
    s_cbranch_vccnz L_sx5_105
    ds_read_b64_tr_b16 v[40:41], v15 offset:40960
    ds_read_b64_tr_b16 v[42:43], v15 offset:42240
    ds_read_b64_tr_b16 v[44:45], v15 offset:40992
    ds_read_b64_tr_b16 v[46:47], v15 offset:42272
    ds_read_b64_tr_b16 v[48:49], v15 offset:41024
    ds_read_b64_tr_b16 v[50:51], v15 offset:42304
    ds_read_b64_tr_b16 v[52:53], v15 offset:41056
    ds_read_b64_tr_b16 v[54:55], v15 offset:42336
    ds_read_b64_tr_b16 v[56:57], v15 offset:41088
    ds_read_b64_tr_b16 v[58:59], v15 offset:42368
    ds_read_b64_tr_b16 v[60:61], v15 offset:41120
    ds_read_b64_tr_b16 v[62:63], v15 offset:42400
    ds_read_b64_tr_b16 v[64:65], v15 offset:41152
    ds_read_b64_tr_b16 v[66:67], v15 offset:42432
    ds_read_b64_tr_b16 v[68:69], v15 offset:41184
    ds_read_b64_tr_b16 v[70:71], v15 offset:42464
    ds_read_b64_tr_b16 v[72:73], v15 offset:41216
    ds_read_b64_tr_b16 v[74:75], v15 offset:42496
    ds_read_b64_tr_b16 v[76:77], v15 offset:41248
    ds_read_b64_tr_b16 v[78:79], v15 offset:42528
    v_add_f32 v120, v120, v121
    v_add_f32 v122, v122, v123
    v_add_f32 v124, v124, v125
    v_add_f32 v126, v126, v127
    v_add_f32 v120, v120, v122
    v_add_f32 v124, v124, v126
    v_cvt_pk_bf16_f32 v120, v120, v120
    v_and_b32 v120, 0xffff0000, v120
    v_cvt_pk_bf16_f32 v124, v124, v124
    v_and_b32 v124, 0xffff0000, v124
    v_mul_f32 v34, v120, v120
    v_mov_b32 v35, 1.0
    v_fmac_f32 v35, 0x3d372713, v34
    v_mul_f32 v35, v35, v120
    v_mul_f32 v35, 0xc0135761, v35
    v_exp_f32 v35, v35
    s_nop 0
    v_add_f32 v35, 1.0, v35
    v_rcp_f32 v35, v35
    s_nop 0
    v_mul_f32 v35, v120, v35
    v_cvt_pk_bf16_f32 v35, v35, v35
    v_and_b32 v35, 0xffff0000, v35
    v_mul_f32 v35, v35, v124
    v_cvt_pk_bf16_f32 v35, v35, v35
    ds_write_b16 v36, v35 offset:7424
    ds_read_b128 v[128:131], v37 offset:7424
    s_waitcnt lgkmcnt(0)
    v_mfma_f32_16x16x32_bf16 v[80:83], v[40:43], v[128:131], 0
    v_mfma_f32_16x16x32_bf16 v[84:87], v[44:47], v[128:131], 0
    v_mfma_f32_16x16x32_bf16 v[88:91], v[48:51], v[128:131], 0
    v_mfma_f32_16x16x32_bf16 v[92:95], v[52:55], v[128:131], 0
    v_mfma_f32_16x16x32_bf16 v[96:99], v[56:59], v[128:131], 0
    s_nop 3
    buffer_store_dwordx4 v[80:83], v38, s[44:47], s97 offen offset:0 sc1
    v_mfma_f32_16x16x32_bf16 v[100:103], v[60:63], v[128:131], 0
    s_nop 2
    buffer_store_dwordx4 v[84:87], v38, s[44:47], s97 offen offset:64 sc1
    v_mfma_f32_16x16x32_bf16 v[104:107], v[64:67], v[128:131], 0
    s_nop 1
    buffer_store_dwordx4 v[88:91], v38, s[44:47], s97 offen offset:128 sc1
    v_mfma_f32_16x16x32_bf16 v[108:111], v[68:71], v[128:131], 0
    s_nop 0
    buffer_store_dwordx4 v[92:95], v38, s[44:47], s97 offen offset:192 sc1
    v_mfma_f32_16x16x32_bf16 v[112:115], v[72:75], v[128:131], 0
    buffer_store_dwordx4 v[96:99], v38, s[44:47], s97 offen offset:256 sc1
    v_mfma_f32_16x16x32_bf16 v[116:119], v[76:79], v[128:131], 0
    buffer_store_dwordx4 v[100:103], v38, s[44:47], s97 offen offset:320 sc1
    s_nop 0
    buffer_store_dwordx4 v[104:107], v38, s[44:47], s97 offen offset:384 sc1
    s_nop 1
    buffer_store_dwordx4 v[108:111], v38, s[44:47], s97 offen offset:448 sc1
    s_nop 2
    buffer_store_dwordx4 v[112:115], v38, s[44:47], s97 offen offset:512 sc1
    s_nop 3
    buffer_store_dwordx4 v[116:119], v38, s[44:47], s97 offen offset:576 sc1
    s_branch L_CEND
L_T4:
    v_lshlrev_b32 v33, 2, v15
    s_lshl_b32 s8, s11, 6
    s_and_b32 s61, s11, 0
    s_mul_i32 s61, s61, 20480
    s_add_u32 s61, s61, s8
    s_mov_b32 s9, 0
L_py1f_106:
    s_add_u32 s9, s9, 1
    s_cmp_gt_u32 s9, 200000
    s_cbranch_scc1 L_BAIL
    s_add_u32 s7, s61, 393216
    buffer_load_dword v120, v33, s[44:47], s7 offen sc1
    s_add_u32 s7, s61, 395776
    buffer_load_dword v121, v33, s[44:47], s7 offen sc1
    s_add_u32 s7, s61, 398336
    buffer_load_dword v122, v33, s[44:47], s7 offen sc1
    s_add_u32 s7, s61, 400896
    buffer_load_dword v123, v33, s[44:47], s7 offen sc1
    s_add_u32 s7, s61, 403456
    buffer_load_dword v124, v33, s[44:47], s7 offen sc1
    s_add_u32 s7, s61, 406016
    buffer_load_dword v125, v33, s[44:47], s7 offen sc1
    s_add_u32 s7, s61, 408576
    buffer_load_dword v126, v33, s[44:47], s7 offen sc1
    s_add_u32 s7, s61, 411136
    buffer_load_dword v127, v33, s[44:47], s7 offen sc1
    s_waitcnt vmcnt(0)
    v_max_u32 v32, v120, v121
    v_max3_u32 v32, v32, v122, v123
    v_max3_u32 v32, v32, v124, v125
    v_max3_u32 v32, v32, v126, v127
    v_cmp_eq_u32 vcc, -1, v32
    s_cbranch_vccnz L_py1f_106
    v_add_f32 v120, v120, v121
    v_add_f32 v122, v122, v123
    v_add_f32 v124, v124, v125
    v_add_f32 v126, v126, v127
    v_add_f32 v120, v120, v122
    v_add_f32 v124, v124, v126
    v_add_f32 v120, v120, v124
    v_cvt_pk_bf16_f32 v120, v120, v120
    v_and_b32 v120, 0xffff0000, v120
    v_mul_f32 v120, v16, v120
    v_cvt_pk_bf16_f32 v120, v120, v120
    v_and_b32 v120, 0xffff0000, v120
    v_add_f32 v21, v20, v120
    v_cvt_pk_bf16_f32 v21, v21, v21
    v_and_b32 v21, 0xffff0000, v21
    s_cmp_lg_u32 s11, 0
    s_cbranch_scc1 L_now_107
    v_mov_b32 v34, s6
    v_cmp_eq_u32 vcc, 0, v1
    v_mov_b32 v35, 0x40000000
    s_nop 0
    v_cndmask_b32 v32, v35, v2, vcc
    buffer_store_dword v34, v32, s[44:47], 0 offen sc1
L_now_107:
    v_lshrrev_b32 v32, 4, v1
    s_mov_b32 s7, 2560
    v_mul_lo_u32 v34, v32, s7
    v_add_u32 v23, v33, v34
    v_cmp_gt_u32 vcc, 2, v32
    v_mov_b32 v35, 0x40000000
    s_nop 0
    v_cndmask_b32 v22, v35, v23, vcc
    s_mov_b32 s60, s38
    s_and_b32 s61, s39, 0xffff
    s_mov_b32 s62, 0x500
    s_mov_b32 s63, 0x20000
    v_lshlrev_b32 v24, 1, v15
    v_cmp_gt_u32 vcc, 16, v1
    v_mov_b32 v35, 0x40000000
    s_nop 0
    v_cndmask_b32 v24, v35, v24, vcc
    s_add_u32 s7, s8, 589824
    buffer_load_dword v40, v23, s[44:47], s7 offen sc1
    s_add_u32 s7, s8, 600064
    buffer_load_dword v41, v23, s[44:47], s7 offen sc1
    s_add_u32 s7, s8, 610304
    buffer_load_dword v42, v23, s[44:47], s7 offen sc1
    s_add_u32 s7, s8, 620544
    buffer_load_dword v43, v23, s[44:47], s7 offen sc1
    s_add_u32 s7, s8, 630784
    buffer_load_dword v44, v23, s[44:47], s7 offen sc1
    s_add_u32 s7, s8, 641024
    buffer_load_dword v45, v23, s[44:47], s7 offen sc1
    s_add_u32 s7, s8, 651264
    buffer_load_dword v46, v23, s[44:47], s7 offen sc1
    s_add_u32 s7, s8, 661504
    buffer_load_dword v47, v23, s[44:47], s7 offen sc1
    s_add_u32 s7, s8, 671744
    buffer_load_dword v48, v23, s[44:47], s7 offen sc1
    s_add_u32 s7, s8, 681984
    buffer_load_dword v49, v23, s[44:47], s7 offen sc1
    s_add_u32 s7, s8, 692224
    buffer_load_dword v50, v23, s[44:47], s7 offen sc1
    s_add_u32 s7, s8, 702464
    buffer_load_dword v51, v23, s[44:47], s7 offen sc1
    s_add_u32 s7, s8, 712704
    buffer_load_dword v52, v23, s[44:47], s7 offen sc1
    s_add_u32 s7, s8, 722944
    buffer_load_dword v53, v22, s[44:47], s7 offen sc1
    s_sleep 4
    s_mov_b32 s9, 0
L_py2_108:
    s_add_u32 s9, s9, 1
    s_cmp_gt_u32 s9, 200000
    s_cbranch_scc1 L_BAIL
    s_add_u32 s7, s8, 589824
    buffer_load_dword v56, v23, s[44:47], s7 offen sc1
    s_add_u32 s7, s8, 600064
    buffer_load_dword v57, v23, s[44:47], s7 offen sc1
    s_add_u32 s7, s8, 610304
    buffer_load_dword v58, v23, s[44:47], s7 offen sc1
    s_add_u32 s7, s8, 620544
    buffer_load_dword v59, v23, s[44:47], s7 offen sc1
    s_add_u32 s7, s8, 630784
    buffer_load_dword v60, v23, s[44:47], s7 offen sc1
    s_add_u32 s7, s8, 641024
    buffer_load_dword v61, v23, s[44:47], s7 offen sc1
    s_add_u32 s7, s8, 651264
    buffer_load_dword v62, v23, s[44:47], s7 offen sc1
    s_add_u32 s7, s8, 661504
    buffer_load_dword v63, v23, s[44:47], s7 offen sc1
    s_add_u32 s7, s8, 671744
    buffer_load_dword v64, v23, s[44:47], s7 offen sc1
    s_add_u32 s7, s8, 681984
    buffer_load_dword v65, v23, s[44:47], s7 offen sc1
    s_add_u32 s7, s8, 692224
    buffer_load_dword v66, v23, s[44:47], s7 offen sc1
    s_add_u32 s7, s8, 702464
    buffer_load_dword v67, v23, s[44:47], s7 offen sc1
    s_add_u32 s7, s8, 712704
    buffer_load_dword v68, v23, s[44:47], s7 offen sc1
    s_add_u32 s7, s8, 722944
    buffer_load_dword v69, v22, s[44:47], s7 offen sc1
    s_waitcnt vmcnt(14)
    v_max_u32 v32, v40, v41
    v_max3_u32 v32, v32, v42, v43
    v_max3_u32 v32, v32, v44, v45
    v_max3_u32 v32, v32, v46, v47
    v_max3_u32 v32, v32, v48, v49
    v_max3_u32 v32, v32, v50, v51
    v_max3_u32 v32, v32, v52, v53
    v_cmp_eq_u32 vcc, -1, v32
    s_cbranch_vccz L_py2_108_ok_110
    s_add_u32 s7, s8, 589824
    buffer_load_dword v40, v23, s[44:47], s7 offen sc1
    s_add_u32 s7, s8, 600064
    buffer_load_dword v41, v23, s[44:47], s7 offen sc1
    s_add_u32 s7, s8, 610304
    buffer_load_dword v42, v23, s[44:47], s7 offen sc1
    s_add_u32 s7, s8, 620544
    buffer_load_dword v43, v23, s[44:47], s7 offen sc1
    s_add_u32 s7, s8, 630784
    buffer_load_dword v44, v23, s[44:47], s7 offen sc1
    s_add_u32 s7, s8, 641024
    buffer_load_dword v45, v23, s[44:47], s7 offen sc1
    s_add_u32 s7, s8, 651264
    buffer_load_dword v46, v23, s[44:47], s7 offen sc1
    s_add_u32 s7, s8, 661504
    buffer_load_dword v47, v23, s[44:47], s7 offen sc1
    s_add_u32 s7, s8, 671744
    buffer_load_dword v48, v23, s[44:47], s7 offen sc1
    s_add_u32 s7, s8, 681984
    buffer_load_dword v49, v23, s[44:47], s7 offen sc1
    s_add_u32 s7, s8, 692224
    buffer_load_dword v50, v23, s[44:47], s7 offen sc1
    s_add_u32 s7, s8, 702464
    buffer_load_dword v51, v23, s[44:47], s7 offen sc1
    s_add_u32 s7, s8, 712704
    buffer_load_dword v52, v23, s[44:47], s7 offen sc1
    s_add_u32 s7, s8, 722944
    buffer_load_dword v53, v22, s[44:47], s7 offen sc1
    s_waitcnt vmcnt(14)
    v_max_u32 v32, v56, v57
    v_max3_u32 v32, v32, v58, v59
    v_max3_u32 v32, v32, v60, v61
    v_max3_u32 v32, v32, v62, v63
    v_max3_u32 v32, v32, v64, v65
    v_max3_u32 v32, v32, v66, v67
    v_max3_u32 v32, v32, v68, v69
    v_cmp_eq_u32 vcc, -1, v32
    s_cbranch_vccz L_py2_108_ok_111
    s_branch L_py2_108
L_py2_108_ok_110:
    v_add_f32 v40, v40, v41
    v_add_f32 v42, v42, v43
    v_add_f32 v44, v44, v45
    v_add_f32 v46, v46, v47
    v_add_f32 v48, v48, v49
    v_add_f32 v50, v50, v51
    v_add_f32 v52, v52, v53
    v_add_f32 v40, v40, v42
    v_add_f32 v44, v44, v46
    v_add_f32 v48, v48, v50
    v_add_f32 v40, v40, v44
    v_add_f32 v48, v48, v52
    v_add_f32 v120, v40, v48
    s_branch L_py2_108_done_109
L_py2_108_ok_111:
    v_add_f32 v56, v56, v57
    v_add_f32 v58, v58, v59
    v_add_f32 v60, v60, v61
    v_add_f32 v62, v62, v63
    v_add_f32 v64, v64, v65
    v_add_f32 v66, v66, v67
    v_add_f32 v68, v68, v69
    v_add_f32 v56, v56, v58
    v_add_f32 v60, v60, v62
    v_add_f32 v64, v64, v66
    v_add_f32 v56, v56, v60
    v_add_f32 v64, v64, v68
    v_add_f32 v120, v56, v64
L_py2_108_done_109:
    v_mov_b32 v34, v120
    s_nop 1
    v_permlane16_swap_b32 v120, v34
    v_add_f32 v120, v120, v34
    v_mov_b32 v34, v120
    s_nop 1
    v_permlane32_swap_b32 v120, v34
    v_add_f32 v120, v120, v34
    v_cvt_pk_bf16_f32 v120, v120, v120
    v_and_b32 v120, 0xffff0000, v120
    v_mul_f32 v120, v18, v120
    v_cvt_pk_bf16_f32 v120, v120, v120
    v_and_b32 v120, 0xffff0000, v120
    v_add_f32 v120, v21, v120
    v_cvt_pk_bf16_f32 v120, v120, v120
    s_lshl_b32 s7, s11, 5
    buffer_store_short v120, v24, s[60:63], s7 offen
L_CEND:
    s_endpgm
L_BAIL:
    s_mov_b64 exec, -1
    v_mov_b32 v34, 1
    v_cmp_eq_u32 vcc, 0, v1
    v_mov_b32 v33, 4
    v_mov_b32 v35, 0x40000000
    v_cndmask_b32 v33, v35, v33, vcc
    buffer_atomic_add v34, v33, s[48:51], 0 offen
    v_mov_b32 v34, -2
    v_mov_b32 v35, -2
    v_mov_b32 v36, -2
    v_mov_b32 v37, -2
    v_lshlrev_b32 v33, 4, v1
    ds_write_b128 v33, v[34:37] offset:12288
    ds_write_b128 v33, v[34:37] offset:13312
    ds_write_b128 v33, v[34:37] offset:14336
    ds_write_b128 v33, v[34:37] offset:15360
    ds_write_b128 v33, v[34:37] offset:16384
    ds_write_b128 v33, v[34:37] offset:17408
    ds_write_b128 v33, v[34:37] offset:18432
    ds_write_b128 v33, v[34:37] offset:19456
    v_mov_b32 v34, 1
    ds_write_b32 v2, v34 offset:11844
    ds_write_b32 v2, v34 offset:11856
    s_endpgm
L_END:
    s_endpgm
.section .rodata,"a"
.p2align 6
.amdhsa_kernel adaLN_cond__mha_block_cached__glu_gated_geglu__decode_kernel
  .amdhsa_next_free_vgpr 168
  .amdhsa_next_free_sgpr 102
  .amdhsa_accum_offset 168
  .amdhsa_group_segment_fixed_size 0
  .amdhsa_kernarg_size 112
  .amdhsa_user_sgpr_count 2
  .amdhsa_user_sgpr_kernarg_segment_ptr 1
  .amdhsa_system_sgpr_workgroup_id_x 1
.end_amdhsa_kernel
```
